```python
import torch

def _softmax(x, axis=-1):
    return torch.softmax(x, dim=axis)
def _gelu(x):
    return torch.nn.functional.gelu(x, approximate="tanh")
def _silu(x):
    return torch.nn.functional.silu(x)
def _sigmoid(x):
    return torch.sigmoid(x)
def _layernorm(x, axis=-1, eps=1e-5):
    m = x.mean(dim=axis, keepdim=True)
    v = x.var(dim=axis, keepdim=True, unbiased=False)
    return (x - m) / torch.sqrt(v + eps)
def _scatter_add(tgt, idx, src, axis=0):
    return tgt.clone().index_add_(axis, idx, src)
def _segment_sum(src, seg, n):
    out = torch.zeros((n,) + src.shape[1:], dtype=src.dtype)
    return out.index_add_(0, seg, src)
def _pad(x, pw):
    flat = tuple(v for pair in reversed(pw) for v in pair)
    return torch.nn.functional.pad(x, flat)

kernel_name = 'parallel_sum__grouped_kv_mqa__glu_gated_reglu__prompt'

def setup_inputs():

    _w = (lambda a: (lambda t: t.to(torch.bfloat16) if t.is_floating_point() else t)(torch.as_tensor(a)))
    def _A_setup():
        B, S, D, H = 1, 2048, 640, 32
        Dh = D // H
        return {
            "x": _w((lambda *s: torch.randn(*s, dtype=torch.bfloat16) * 0.05)(B, S, D)),
            "wq": _w((lambda *s: torch.randn(*s, dtype=torch.bfloat16) * 0.05)(D, H * Dh)),
            "wk": _w((lambda *s: torch.randn(*s, dtype=torch.bfloat16) * 0.05)(D, Dh)),
            "wv": _w((lambda *s: torch.randn(*s, dtype=torch.bfloat16) * 0.05)(D, Dh)),
            "wo": _w((lambda *s: torch.randn(*s, dtype=torch.bfloat16) * 0.05)(H * Dh, D)),
        }
    _A_in = _A_setup()

    def _B_setup():
        B, S, D, F = 1, 2048, 640, 1728
        return {
            "x": _w((lambda *s: torch.randn(*s, dtype=torch.bfloat16) * 0.05)(B, S, D)),
            "W_gate": _w((lambda *s: torch.randn(*s, dtype=torch.bfloat16) * 0.8)(D, F) * (2.0 / D) ** 0.5),
            "W_up": _w((lambda *s: torch.randn(*s, dtype=torch.bfloat16) * 0.8)(D, F) * (2.0 / D) ** 0.5),
            "W_down": _w((lambda *s: torch.randn(*s, dtype=torch.bfloat16) * 0.8)(F, D) * (1.0 / F) ** 0.5),
        }
    _B_in = _B_setup()

    return {
        "A_x": _A_in["x"],
        "A_wq": _A_in["wq"],
        "A_wk": _A_in["wk"],
        "A_wv": _A_in["wv"],
        "A_wo": _A_in["wo"],
        "B_x": _B_in["x"],
        "B_W_gate": _B_in["W_gate"],
        "B_W_up": _B_in["W_up"],
        "B_W_down": _B_in["W_down"],
    }

def reference(A_x, A_wq, A_wk, A_wv, A_wo, B_x, B_W_gate, B_W_up, B_W_down):
    def _A_ref(x, wq, wk, wv, wo):
        B, S, D = x.shape
        H = 32
        Dh = D // H
        q = (lambda x, *d: x.permute(*d))((x @ wq).reshape(B, S, H, Dh), 0, 2, 1, 3)
        k = x @ wk
        v = x @ wv
        scores = torch.einsum("bhqd,bkd->bhqk", q, k) * (Dh ** -0.5)
        p = _softmax(scores, axis=-1)
        o = torch.einsum("bhqk,bkd->bhqd", p, v)
        return (lambda x, *d: x.permute(*d))(o, 0, 2, 1, 3).reshape(B, S, H * Dh) @ wo

    def _B_ref(x, W_gate, W_up, W_down):
        gate = torch.einsum("bsd,df->bsf", x, W_gate)
        up = torch.einsum("bsd,df->bsf", x, W_up)
        gate = gate * (lambda x, dt: x.to(dt))(gate > 0, gate.dtype)
        h = gate * up
        return torch.einsum("bsf,fd->bsd", h, W_down)

    x = A_x
    xn = _layernorm(x, axis=-1)
    return x + _A_ref(xn, A_wq, A_wk, A_wv, A_wo) + _B_ref(xn, B_W_gate, B_W_up, B_W_down)
```

```asm
; @launch kernel=parallel_sum__grouped_kv_mqa__glu_gated_reglu__prompt_kernel grid=(256,1,1) block=(512,1,1) lds=163840
.amdgcn_target "amdgcn-amd-amdhsa--gfx950"
.text
.globl parallel_sum__grouped_kv_mqa__glu_gated_reglu__prompt_kernel
.p2align 8
.type parallel_sum__grouped_kv_mqa__glu_gated_reglu__prompt_kernel,@function
parallel_sum__grouped_kv_mqa__glu_gated_reglu__prompt_kernel:
    s_cmp_ge_u32 s2, 256
    s_cbranch_scc1 L_m_done
    s_load_dwordx8 s[52:59], s[0:1], 0
    s_load_dwordx4 s[8:11], s[0:1], 48
    s_load_dwordx4 s[4:7], s[0:1], 80
    s_load_dwordx2 s[60:61], s[0:1], 64
    s_load_dwordx2 s[62:63], s[0:1], 32
    s_load_dwordx2 s[84:85], s[0:1], 72
    s_getpc_b64 s[20:21]
    s_and_b32 s20, s20, 0xffffff00
    s_mov_b32 s22, L_code_end-parallel_sum__grouped_kv_mqa__glu_gated_reglu__prompt_kernel
    s_mov_b32 s23, 0x20000
    s_lshr_b32 s33, s2, 3
    s_lshl_b32 s33, s33, 7
    v_lshlrev_b32 v126, 12, v0
    buffer_load_dword v127, v126, s[20:23], s33 offen
    v_lshrrev_b32 v3, 6, v0
    v_and_b32 v1, 63, v0
    v_readfirstlane_b32 s28, v3
    s_and_b32 s29, s2, 1
    s_lshl_b32 s29, s29, 2
    s_bfe_u32 s33, s2, 0x20003
    s_add_u32 s29, s29, s33
    s_bfe_u32 s30, s2, 0x20001
    s_lshr_b32 s33, s2, 5
    s_lshl_b32 s33, s33, 2
    s_lshr_b32 s3, s2, 6
    s_lshl_b32 s3, s3, 2
    s_add_u32 s3, s3, s30
    s_add_u32 s30, s30, s33
    s_cmp_eq_u32 s30, 23
    s_cselect_b32 s33, 27, s30
    s_cmp_eq_u32 s30, 27
    s_cselect_b32 s30, 23, s33
    s_cmp_ge_u32 s28, 4
    s_cbranch_scc1 L_k1_loader
    v_lshrrev_b32 v3, 4, v1
    v_and_b32 v2, 15, v1
    s_lshl_b32 s36, s28, 2
    v_add_u32 v15, s36, v3
    v_mul_u32_u24 v14, 1280, v15
    v_lshl_add_u32 v14, v2, 4, v14
    s_lshl_b32 s36, s29, 4
    s_add_u32 s36, s36, s3
    s_mul_i32 s37, s36, 20480
    s_bitcmp1_b32 s2, 5
    s_waitcnt lgkmcnt(0)
    s_cbranch_scc1 L_k1_compute
    s_mov_b32 s12, s52
    s_mov_b32 s13, s53
    s_mov_b32 s14, 0x280000
    s_mov_b32 s15, 0x20000
    buffer_load_dwordx4 v[56:59], v14, s[12:15], s37 offen offset:0
    buffer_load_dwordx4 v[60:63], v14, s[12:15], s37 offen offset:256
    buffer_load_dwordx4 v[64:67], v14, s[12:15], s37 offen offset:512
    buffer_load_dwordx4 v[68:71], v14, s[12:15], s37 offen offset:768
    buffer_load_dwordx4 v[72:75], v14, s[12:15], s37 offen offset:1024
    v_lshlrev_b32 v88, 3, v15
    v_add_u32 v88, 20736, v88
    v_lshl_add_u32 v90, v15, 4, v14
    s_mov_b32 s42, 0xffff0000
    s_branch L_k1_stats
L_k1_loader:
    s_sub_u32 s31, s28, 4
    v_lshrrev_b32 v2, 3, v1
    v_and_b32 v3, 7, v1
    v_lshrrev_b32 v4, 4, v1
    s_lshl_b32 s37, s29, 8
    s_lshl_b32 s38, s31, 6
    s_add_u32 s37, s37, s38
    v_add_u32 v6, s37, v2
    v_mul_u32_u24 v6, 1280, v6
    v_xor_b32 v7, v4, v3
    v_lshl_add_u32 v8, v7, 4, v6
    v_xor_b32 v7, 4, v7
    v_lshl_add_u32 v9, v7, 4, v6
    v_add_u32 v9, 10240, v9
    v_add_u32 v10, 20480, v8
    v_add_u32 v11, 20480, v9
    v_add_u32 v12, 40960, v8
    v_add_u32 v13, 40960, v9
    v_add_u32 v14, 61440, v8
    v_add_u32 v15, 61440, v9
    s_lshl_b32 s40, s31, 13
    s_lshl_b32 s41, s31, 12
    s_add_u32 s41, s41, 32768
    s_mov_b32 s43, 0
    s_mov_b32 s44, 0
    s_lshr_b32 s34, s31, 1
    s_lshl_b32 s35, s30, 7
    s_sub_u32 s45, s30, 27
    s_lshl_b32 s45, s45, 8
    s_lshl_b32 s46, s34, 7
    s_add_u32 s45, s45, s46
    s_cmp_lt_u32 s30, 27
    s_cselect_b32 s35, s35, s45
    s_movk_i32 s46, 1280
    s_cselect_b32 s36, 3456, s46
    v_and_b32 v61, 1, v4
    v_lshlrev_b32 v61, 1, v61
    v_xor_b32 v61, v61, v3
    v_lshl_add_u32 v5, v61, 4, s35
    s_and_b32 s37, s31, 1
    s_lshl_b32 s37, s37, 5
    v_add_u32 v6, s37, v2
    v_mad_u32_u24 v16, v6, s36, v5
    s_lshl_b32 s37, s36, 3
    v_xor_b32 v17, 64, v16
    v_add_u32 v17, s37, v17
    s_lshl_b32 s37, s36, 4
    v_add_u32 v18, s37, v16
    v_add_u32 v19, s37, v17
    s_lshl_b32 s42, s36, 6
    s_and_b32 s37, s31, 1
    s_lshl_b32 s37, s37, 5
    s_lshl_b32 s45, s29, 2
    s_add_u32 s37, s37, s45
    v_lshrrev_b32 v35, 2, v1
    v_and_b32 v36, 3, v1
    v_lshl_add_u32 v36, v35, 6, v36
    v_add_u32 v36, s37, v36
    v_mov_b32 v37, s35
    v_mad_u32_u24 v36, v36, s36, v37
    s_waitcnt lgkmcnt(0)
    s_mov_b32 s12, s52
    s_mov_b32 s13, s53
    s_mov_b32 s14, 0x280000
    s_mov_b32 s15, 0x20000
    s_cmp_eq_u32 s34, 0
    s_cselect_b32 s16, s8, s10
    s_cselect_b32 s17, s9, s11
    s_cmp_lt_u32 s30, 27
    s_cselect_b32 s16, s16, s54
    s_cselect_b32 s17, s17, s55
    s_mov_b32 s45, 819200
    s_cselect_b32 s18, 2211840, s45
    s_mov_b32 s19, 0x20000
    v_lshlrev_b32 v22, 4, v1
    s_bitcmp1_b32 s2, 5
    s_cbranch_scc1 L_k1_nokvw
    s_mul_i32 s48, s31, 6400
    s_mov_b32 s20, s56
    s_mov_b32 s21, s57
    s_mov_b32 s22, 0x6400
    s_mov_b32 s23, 0x20000
    s_add_u32 m0, s48, 20992
    s_add_u32 s46, s48, 0
    buffer_load_dwordx4 v22, s[20:23], s46 offen offset:0 lds
    buffer_load_dwordx4 v22, s[20:23], s46 offen offset:1024 lds
    buffer_load_dwordx4 v22, s[20:23], s46 offen offset:2048 lds
    buffer_load_dwordx4 v22, s[20:23], s46 offen offset:3072 lds
    s_add_u32 m0, s48, 25088
    s_add_u32 s46, s48, 4096
    buffer_load_dwordx4 v22, s[20:23], s46 offen offset:0 lds
    buffer_load_dwordx4 v22, s[20:23], s46 offen offset:1024 lds
    s_mov_b64 exec, 0xffff
    buffer_load_dwordx4 v22, s[20:23], s46 offen offset:2048 lds
    s_mov_b64 exec, -1
    s_mov_b32 s20, s58
    s_mov_b32 s21, s59
    s_mov_b32 s22, 0x6400
    s_mov_b32 s23, 0x20000
    s_add_u32 m0, s48, 138176
    s_add_u32 s46, s48, 0
    buffer_load_dwordx4 v22, s[20:23], s46 offen offset:0 lds
    buffer_load_dwordx4 v22, s[20:23], s46 offen offset:1024 lds
    buffer_load_dwordx4 v22, s[20:23], s46 offen offset:2048 lds
    buffer_load_dwordx4 v22, s[20:23], s46 offen offset:3072 lds
    s_add_u32 m0, s48, 142272
    s_add_u32 s46, s48, 4096
    buffer_load_dwordx4 v22, s[20:23], s46 offen offset:0 lds
    buffer_load_dwordx4 v22, s[20:23], s46 offen offset:1024 lds
    s_mov_b64 exec, 0xffff
    buffer_load_dwordx4 v22, s[20:23], s46 offen offset:2048 lds
    s_mov_b64 exec, -1
L_k1_nokvw:
    s_add_u32 m0, s41, 49152
    s_nop 0
    buffer_load_dwordx4 v16, s[16:19], s44 offen lds
    s_add_u32 m0, s41, 50176
    s_nop 0
    buffer_load_dwordx4 v17, s[16:19], s44 offen lds
    s_add_u32 m0, s41, 51200
    s_nop 0
    buffer_load_dwordx4 v18, s[16:19], s44 offen lds
    s_add_u32 m0, s41, 52224
    s_nop 0
    buffer_load_dwordx4 v19, s[16:19], s44 offen lds
    s_add_u32 s44, s44, s42
    s_mov_b32 exec_lo, 0xffff0
    s_mov_b32 exec_hi, 0x0
    buffer_load_dword v38, v36, s[16:19], 0 offen
    s_mov_b64 exec, -1
    s_add_u32 m0, s40, 49152
    s_nop 0
    buffer_load_dwordx4 v8, s[12:15], s43 offen lds
    s_add_u32 m0, s40, 50176
    s_nop 0
    buffer_load_dwordx4 v9, s[12:15], s43 offen lds
    s_add_u32 m0, s40, 51200
    s_nop 0
    buffer_load_dwordx4 v10, s[12:15], s43 offen lds
    s_add_u32 m0, s40, 52224
    s_nop 0
    buffer_load_dwordx4 v11, s[12:15], s43 offen lds
    s_add_u32 m0, s40, 53248
    s_nop 0
    buffer_load_dwordx4 v12, s[12:15], s43 offen lds
    s_add_u32 m0, s40, 54272
    s_nop 0
    buffer_load_dwordx4 v13, s[12:15], s43 offen lds
    s_add_u32 m0, s40, 55296
    s_nop 0
    buffer_load_dwordx4 v14, s[12:15], s43 offen lds
    s_add_u32 m0, s40, 56320
    s_nop 0
    buffer_load_dwordx4 v15, s[12:15], s43 offen lds
    s_add_u32 s43, s43, 128
    s_mov_b32 s24, s6
    s_mov_b32 s25, s7
    s_mov_b32 s26, 0x1400000
    s_mov_b32 s27, 0x20000
    s_mov_b32 s20, s4
    s_mov_b32 s21, s5
    s_mov_b32 s22, 0x100
    s_mov_b32 s23, 0x20000
    s_lshl_b32 s47, s29, 5
    v_mov_b32 v20, 0
    v_and_b32 v23, 15, v1
    v_lshlrev_b32 v26, 3, v1
    v_lshlrev_b32 v63, 5, v3
    s_lshl_b32 s45, s29, 11
    s_lshl_b32 s46, s31, 9
    s_add_u32 s86, s45, s46
    s_add_u32 s86, s86, 5832704
    s_lshl_b32 s46, s3, 7
    s_add_u32 s87, s45, s46
    s_add_u32 s87, s87, 5832704
    v_add_u32 v39, 20736, v26
    s_lshl_b32 s45, s31, 9
    s_add_u32 s45, s45, 161792
    v_add_u32 v33, s45, v26
    s_bitcmp1_b32 s2, 5
    s_cbranch_scc1 L_k1_nokvj
    s_and_b32 s51, s31, 1
    v_mul_u32_u24 v24, 1296, v23
    v_lshl_add_u32 v24, v4, 4, v24
    v_lshrrev_b32 v25, 2, v23
    v_lshl_add_u32 v25, v4, 3, v25
    v_mul_u32_u24 v25, 40, v25
    v_and_b32 v56, 3, v1
    v_lshl_add_u32 v25, v56, 3, v25
    s_mul_i32 s46, s34, 117184
    s_lshl_b32 s50, s51, 5
    s_add_u32 s46, s46, s50
    s_add_u32 s46, s46, 20992
    v_add_u32 v25, s46, v25
    s_lshl_b32 s46, s29, 3
    s_lshr_b32 s50, s3, 1
    s_add_u32 s46, s46, s50
    s_mul_i32 s88, s46, 3584
    s_add_u32 s88, s88, 5242880
    s_and_b32 s89, s3, 1
    v_mov_b32 v60, 0
    s_mov_b64 s[82:83], -1
    s_cmp_lt_u32 s31, 2
    s_cbranch_scc0 L_k1_fv
    s_lshl_b32 s46, s89, 4
    v_add_u32 v56, s46, v23
    s_cmp_eq_u32 s31, 0
    s_cbranch_scc0 L_k1_fk1
    v_and_b32 v57, 1, v4
    v_lshl_add_u32 v57, v57, 5, v56
    v_lshlrev_b32 v57, 4, v57
    v_lshrrev_b32 v55, 1, v4
    v_lshl_add_u32 v57, v55, 3, v57
    s_mov_b64 s[80:81], -1
    s_branch L_k1_fe
L_k1_fk1:
    v_mov_b32 v58, 0x3f803f80
    v_mov_b32 v59, 0x00003f80
    v_lshlrev_b32 v57, 8, v4
    v_lshl_add_u32 v57, v56, 3, v57
    s_add_u32 s88, s88, 3072
    s_mov_b64 s[80:81], 0xffff
    s_mov_b32 s83, 0
    s_branch L_k1_fe
L_k1_fv:
    s_lshl_b32 s46, s51, 4
    v_add_u32 v56, s46, v23
    v_and_b32 v58, 27, v56
    v_cmp_eq_u32 vcc, 24, v58
    v_mov_b32 v59, 0x3f803f80
    v_lshrrev_b32 v57, 1, v4
    v_cndmask_b32 v58, 0, v59, vcc
    v_cmp_gt_u32 s[80:81], 20, v56
    v_lshl_add_u32 v57, v57, 5, v56
    v_lshlrev_b32 v57, 4, v57
    v_and_b32 v55, 1, v4
    v_lshl_add_u32 v57, v55, 3, v57
    v_mov_b32 v59, v58
    s_lshl_b32 s46, s89, 10
    s_add_u32 s88, s88, s46
    s_add_u32 s88, s88, 1024
    s_cmp_eq_u32 s31, 3
    s_cselect_b32 s82, 0xffcfffcf, -1
    s_mov_b32 s83, s82
    s_cselect_b32 s46, 20, 21
    s_lshl_b32 s46, s46, 4
    v_lshl_add_u32 v60, v1, 9, s46
L_k1_fe:
    s_waitcnt vmcnt(13)
    s_barrier
    ds_read_b64 v[40:41], v39
    ds_read_b128 v[64:67], v24 offset:0
    ds_read_b64_tr_b16 v[68:69], v25 offset:0
    ds_read_b64_tr_b16 v[70:71], v25 offset:160
    ds_read_b128 v[72:75], v24 offset:64
    ds_read_b64_tr_b16 v[76:77], v25 offset:1280
    ds_read_b64_tr_b16 v[78:79], v25 offset:1440
    ds_read_b128 v[80:83], v24 offset:128
    ds_read_b64_tr_b16 v[84:85], v25 offset:2560
    ds_read_b64_tr_b16 v[86:87], v25 offset:2720
    ds_read_b128 v[88:91], v24 offset:192
    ds_read_b64_tr_b16 v[92:93], v25 offset:3840
    ds_read_b64_tr_b16 v[94:95], v25 offset:4000
    s_add_u32 m0, s40, 98304
    s_nop 0
    buffer_load_dwordx4 v8, s[12:15], s43 offen lds
    ds_read_b128 v[96:99], v24 offset:256
    ds_read_b64_tr_b16 v[100:101], v25 offset:5120
    ds_read_b64_tr_b16 v[102:103], v25 offset:5280
    ds_read_b128 v[104:107], v24 offset:320
    ds_read_b64_tr_b16 v[108:109], v25 offset:6400
    ds_read_b64_tr_b16 v[110:111], v25 offset:6560
    s_add_u32 m0, s40, 99328
    s_nop 0
    buffer_load_dwordx4 v9, s[12:15], s43 offen lds
    ds_read_b128 v[112:115], v24 offset:384
    ds_read_b64_tr_b16 v[116:117], v25 offset:7680
    ds_read_b64_tr_b16 v[118:119], v25 offset:7840
    ds_read_b128 v[120:123], v24 offset:448
    ds_read_b64_tr_b16 v[124:125], v25 offset:8960
    ds_read_b64_tr_b16 v[126:127], v25 offset:9120
    s_add_u32 m0, s40, 100352
    s_nop 0
    buffer_load_dwordx4 v10, s[12:15], s43 offen lds
    ds_read_b128 v[128:131], v24 offset:512
    ds_read_b64_tr_b16 v[132:133], v25 offset:10240
    ds_read_b64_tr_b16 v[134:135], v25 offset:10400
    ds_read_b128 v[136:139], v24 offset:576
    ds_read_b64_tr_b16 v[140:141], v25 offset:11520
    ds_read_b64_tr_b16 v[142:143], v25 offset:11680
    s_add_u32 m0, s40, 101376
    s_nop 0
    buffer_load_dwordx4 v11, s[12:15], s43 offen lds
    ds_read_b128 v[144:147], v24 offset:640
    ds_read_b64_tr_b16 v[148:149], v25 offset:12800
    ds_read_b64_tr_b16 v[150:151], v25 offset:12960
    ds_read_b128 v[152:155], v24 offset:704
    ds_read_b64_tr_b16 v[156:157], v25 offset:14080
    ds_read_b64_tr_b16 v[158:159], v25 offset:14240
    s_add_u32 m0, s40, 102400
    s_nop 0
    buffer_load_dwordx4 v12, s[12:15], s43 offen lds
    ds_read_b128 v[160:163], v24 offset:768
    ds_read_b64_tr_b16 v[164:165], v25 offset:15360
    ds_read_b64_tr_b16 v[166:167], v25 offset:15520
    ds_read_b128 v[168:171], v24 offset:832
    ds_read_b64_tr_b16 v[172:173], v25 offset:16640
    ds_read_b64_tr_b16 v[174:175], v25 offset:16800
    s_add_u32 m0, s40, 103424
    s_nop 0
    buffer_load_dwordx4 v13, s[12:15], s43 offen lds
    ds_read_b128 v[176:179], v24 offset:896
    ds_read_b64_tr_b16 v[180:181], v25 offset:17920
    ds_read_b64_tr_b16 v[182:183], v25 offset:18080
    ds_read_b128 v[184:187], v24 offset:960
    ds_read_b64_tr_b16 v[188:189], v25 offset:19200
    ds_read_b64_tr_b16 v[190:191], v25 offset:19360
    s_add_u32 m0, s40, 104448
    s_nop 0
    buffer_load_dwordx4 v14, s[12:15], s43 offen lds
    ds_read_b128 v[192:195], v24 offset:1024
    ds_read_b64_tr_b16 v[196:197], v25 offset:20480
    ds_read_b64_tr_b16 v[198:199], v25 offset:20640
    ds_read_b128 v[200:203], v24 offset:1088
    ds_read_b64_tr_b16 v[204:205], v25 offset:21760
    ds_read_b64_tr_b16 v[206:207], v25 offset:21920
    s_add_u32 m0, s40, 105472
    s_nop 0
    buffer_load_dwordx4 v15, s[12:15], s43 offen lds
    s_add_u32 s43, s43, 128
    ds_read_b128 v[208:211], v24 offset:1152
    ds_read_b64_tr_b16 v[212:213], v25 offset:23040
    ds_read_b64_tr_b16 v[214:215], v25 offset:23200
    ds_read_b128 v[216:219], v24 offset:1216
    ds_read_b64_tr_b16 v[220:221], v25 offset:24320
    ds_read_b64_tr_b16 v[222:223], v25 offset:24480
    s_waitcnt vmcnt(8) lgkmcnt(0)
    s_barrier
    s_add_u32 m0, s41, 98304
    s_nop 0
    buffer_load_dwordx4 v16, s[16:19], s44 offen lds
    s_add_u32 m0, s41, 99328
    s_nop 0
    buffer_load_dwordx4 v17, s[16:19], s44 offen lds
    s_add_u32 m0, s41, 100352
    s_nop 0
    buffer_load_dwordx4 v18, s[16:19], s44 offen lds
    s_add_u32 m0, s41, 101376
    s_nop 0
    buffer_load_dwordx4 v19, s[16:19], s44 offen lds
    s_add_u32 s44, s44, s42
    s_add_u32 m0, s41, 0
    s_nop 0
    buffer_load_dwordx4 v16, s[16:19], s44 offen lds
    s_add_u32 m0, s41, 1024
    s_nop 0
    buffer_load_dwordx4 v17, s[16:19], s44 offen lds
    s_add_u32 m0, s41, 2048
    s_nop 0
    buffer_load_dwordx4 v18, s[16:19], s44 offen lds
    s_add_u32 m0, s41, 3072
    s_nop 0
    buffer_load_dwordx4 v19, s[16:19], s44 offen lds
    s_add_u32 s44, s44, s42
    s_add_u32 m0, s40, 0
    s_nop 0
    buffer_load_dwordx4 v8, s[12:15], s43 offen lds
    s_add_u32 m0, s40, 1024
    s_nop 0
    buffer_load_dwordx4 v9, s[12:15], s43 offen lds
    s_add_u32 m0, s40, 2048
    s_nop 0
    buffer_load_dwordx4 v10, s[12:15], s43 offen lds
    s_add_u32 m0, s40, 3072
    s_nop 0
    buffer_load_dwordx4 v11, s[12:15], s43 offen lds
    s_add_u32 m0, s40, 4096
    s_nop 0
    buffer_load_dwordx4 v12, s[12:15], s43 offen lds
    s_mov_b32 exec_lo, 0xfff00000
    s_mov_b32 exec_hi, 0xff
    buffer_load_dword v38, v36, s[16:19], 0 offen
    s_mov_b64 exec, -1
    s_branch L_k1_join
L_k1_nokvj:
    v_mov_b32 v57, 0
    v_mov_b32 v60, 0
    s_add_u32 m0, s41, 98304
    s_nop 0
    buffer_load_dwordx4 v16, s[16:19], s44 offen lds
    s_add_u32 m0, s41, 99328
    s_nop 0
    buffer_load_dwordx4 v17, s[16:19], s44 offen lds
    s_add_u32 m0, s41, 100352
    s_nop 0
    buffer_load_dwordx4 v18, s[16:19], s44 offen lds
    s_add_u32 m0, s41, 101376
    s_nop 0
    buffer_load_dwordx4 v19, s[16:19], s44 offen lds
    s_add_u32 s44, s44, s42
    s_add_u32 m0, s40, 98304
    s_nop 0
    buffer_load_dwordx4 v8, s[12:15], s43 offen lds
    s_add_u32 m0, s40, 99328
    s_nop 0
    buffer_load_dwordx4 v9, s[12:15], s43 offen lds
    s_bfe_u32 s45, s2, 0x20005
    s_cmp_ge_u32 s30, 27
    s_cbranch_scc1 L_k1_shallow
    s_cmp_eq_u32 s45, 1
    s_cbranch_scc1 L_k1_deep0
    s_branch L_k1_shallow
L_k1_deep0:
    s_add_u32 m0, s40, 100352
    s_nop 0
    buffer_load_dwordx4 v10, s[12:15], s43 offen lds
    s_add_u32 m0, s40, 101376
    s_nop 0
    buffer_load_dwordx4 v11, s[12:15], s43 offen lds
    s_add_u32 m0, s40, 102400
    s_nop 0
    buffer_load_dwordx4 v12, s[12:15], s43 offen lds
    s_add_u32 m0, s40, 103424
    s_nop 0
    buffer_load_dwordx4 v13, s[12:15], s43 offen lds
    s_add_u32 m0, s40, 104448
    s_nop 0
    buffer_load_dwordx4 v14, s[12:15], s43 offen lds
    s_add_u32 m0, s40, 105472
    s_nop 0
    buffer_load_dwordx4 v15, s[12:15], s43 offen lds
    s_add_u32 s43, s43, 128
    s_add_u32 m0, s41, 0
    s_nop 0
    buffer_load_dwordx4 v16, s[16:19], s44 offen lds
    s_add_u32 m0, s41, 1024
    s_nop 0
    buffer_load_dwordx4 v17, s[16:19], s44 offen lds
    s_add_u32 m0, s41, 2048
    s_nop 0
    buffer_load_dwordx4 v18, s[16:19], s44 offen lds
    s_waitcnt vmcnt(15)
    s_barrier
    s_add_u32 m0, s41, 3072
    s_nop 0
    buffer_load_dwordx4 v19, s[16:19], s44 offen lds
    s_add_u32 s44, s44, s42
    s_add_u32 m0, s40, 0
    s_nop 0
    buffer_load_dwordx4 v8, s[12:15], s43 offen lds
    s_add_u32 m0, s40, 1024
    s_nop 0
    buffer_load_dwordx4 v9, s[12:15], s43 offen lds
    s_add_u32 m0, s40, 2048
    s_nop 0
    buffer_load_dwordx4 v10, s[12:15], s43 offen lds
    s_add_u32 m0, s40, 3072
    s_nop 0
    buffer_load_dwordx4 v11, s[12:15], s43 offen lds
    s_add_u32 m0, s40, 4096
    s_nop 0
    buffer_load_dwordx4 v12, s[12:15], s43 offen lds
    s_mov_b32 exec_lo, 0xfff00000
    s_mov_b32 exec_hi, 0xff
    buffer_load_dword v38, v36, s[16:19], 0 offen
    s_mov_b64 exec, -1
    s_branch L_k1_join
L_k1_shallow:
    s_waitcnt vmcnt(6)
    s_barrier
    s_add_u32 m0, s40, 100352
    s_nop 0
    buffer_load_dwordx4 v10, s[12:15], s43 offen lds
    s_add_u32 m0, s40, 101376
    s_nop 0
    buffer_load_dwordx4 v11, s[12:15], s43 offen lds
    s_add_u32 m0, s40, 102400
    s_nop 0
    buffer_load_dwordx4 v12, s[12:15], s43 offen lds
    s_add_u32 m0, s40, 103424
    s_nop 0
    buffer_load_dwordx4 v13, s[12:15], s43 offen lds
    s_add_u32 m0, s40, 104448
    s_nop 0
    buffer_load_dwordx4 v14, s[12:15], s43 offen lds
    s_add_u32 m0, s40, 105472
    s_nop 0
    buffer_load_dwordx4 v15, s[12:15], s43 offen lds
    s_add_u32 s43, s43, 128
    s_add_u32 m0, s41, 0
    s_nop 0
    buffer_load_dwordx4 v16, s[16:19], s44 offen lds
    s_add_u32 m0, s41, 1024
    s_nop 0
    buffer_load_dwordx4 v17, s[16:19], s44 offen lds
    s_add_u32 m0, s41, 2048
    s_nop 0
    buffer_load_dwordx4 v18, s[16:19], s44 offen lds
    s_add_u32 m0, s41, 3072
    s_nop 0
    buffer_load_dwordx4 v19, s[16:19], s44 offen lds
    s_add_u32 s44, s44, s42
    s_add_u32 m0, s40, 0
    s_nop 0
    buffer_load_dwordx4 v8, s[12:15], s43 offen lds
    s_add_u32 m0, s40, 1024
    s_nop 0
    buffer_load_dwordx4 v9, s[12:15], s43 offen lds
    s_add_u32 m0, s40, 2048
    s_nop 0
    buffer_load_dwordx4 v10, s[12:15], s43 offen lds
    s_add_u32 m0, s40, 3072
    s_nop 0
    buffer_load_dwordx4 v11, s[12:15], s43 offen lds
    s_add_u32 m0, s40, 4096
    s_nop 0
    buffer_load_dwordx4 v12, s[12:15], s43 offen lds
    s_mov_b32 exec_lo, 0xfff00000
    s_mov_b32 exec_hi, 0xff
    buffer_load_dword v38, v36, s[16:19], 0 offen
    s_mov_b64 exec, -1
L_k1_join:
    s_waitcnt vmcnt(10)
    s_barrier
    buffer_load_dword v27, v63, s[20:23], 0 offen sc1
    s_add_u32 m0, s40, 5120
    s_nop 0
    buffer_load_dwordx4 v13, s[12:15], s43 offen lds
    s_lshl_b32 s45, s2, 2
    s_add_u32 s45, s45, s31
    s_sub_u32 s46, s45, 740
    s_cselect_b32 s45, s45, s46
    s_mul_i32 s46, s45, 6554
    s_lshr_b32 s46, s46, 16
    s_add_u32 m0, s40, 6144
    s_nop 0
    buffer_load_dwordx4 v14, s[12:15], s43 offen lds
    s_mul_i32 s50, s46, 10
    s_sub_u32 s45, s45, s50
    s_mul_i32 s39, s46, 40960
    s_lshl_b32 s50, s45, 12
    s_add_u32 s33, s39, s50
    s_add_u32 s33, s33, 0
    s_add_u32 m0, s40, 7168
    s_nop 0
    buffer_load_dwordx4 v15, s[12:15], s43 offen lds
    s_add_u32 s43, s43, 128
    s_sub_u32 s50, s39, 2211840
    s_cmp_lt_u32 s46, 54
    s_cselect_b32 s39, s39, s50
    s_cselect_b32 s8, s60, s62
    s_cselect_b32 s9, s61, s63
    s_mov_b32 s50, 819200
    s_cselect_b32 s10, 2211840, s50
    s_mov_b32 s11, 0x20000
    s_cselect_b32 s32, 4, 8
    s_movk_i32 s50, 512
    s_cselect_b32 s51, 2048, s50
    s_add_u32 m0, s41, 49152
    s_nop 0
    buffer_load_dwordx4 v16, s[16:19], s44 offen lds
    s_lshl_b32 s45, s45, 7
    s_add_u32 s39, s39, s45
    v_mul_u32_u24 v30, 1280, v2
    v_lshl_add_u32 v30, v3, 4, v30
    s_add_u32 m0, s41, 50176
    s_nop 0
    buffer_load_dwordx4 v17, s[16:19], s44 offen lds
    s_lshl_b32 s49, s31, 12
    s_add_u32 s49, s49, 147456
    v_lshrrev_b32 v32, 2, v23
    v_mad_u32_u24 v32, v4, s32, v32
    v_lshlrev_b32 v32, 7, v32
    v_and_b32 v34, 3, v1
    s_add_u32 m0, s41, 51200
    s_nop 0
    buffer_load_dwordx4 v18, s[16:19], s44 offen lds
    v_lshl_add_u32 v32, v34, 3, v32
    v_add_u32 v32, s49, v32
    v_add_u32 v34, s51, v32
    s_add_u32 m0, s41, 52224
    s_nop 0
    buffer_load_dwordx4 v19, s[16:19], s44 offen lds
    s_add_u32 s44, s44, s42
    s_add_u32 m0, s40, 49152
    s_nop 0
    buffer_load_dwordx4 v8, s[12:15], s43 offen lds
    s_add_u32 m0, s40, 50176
    s_nop 0
    buffer_load_dwordx4 v9, s[12:15], s43 offen lds
    s_add_u32 m0, s40, 51200
    s_nop 0
    buffer_load_dwordx4 v10, s[12:15], s43 offen lds
    s_add_u32 m0, s40, 52224
    s_nop 0
    buffer_load_dwordx4 v11, s[12:15], s43 offen lds
    s_add_u32 m0, s40, 53248
    s_nop 0
    buffer_load_dwordx4 v12, s[12:15], s43 offen lds
    s_add_u32 m0, s40, 54272
    s_nop 0
    buffer_load_dwordx4 v13, s[12:15], s43 offen lds
    s_add_u32 m0, s40, 55296
    s_nop 0
    buffer_load_dwordx4 v14, s[12:15], s43 offen lds
    s_add_u32 m0, s40, 56320
    s_nop 0
    buffer_load_dwordx4 v15, s[12:15], s43 offen lds
    s_add_u32 s43, s43, 128
    s_waitcnt lgkmcnt(0)
    s_waitcnt vmcnt(12)
    s_barrier
    s_add_u32 m0, s41, 98304
    s_nop 0
    buffer_load_dwordx4 v16, s[16:19], s44 offen lds
    s_add_u32 m0, s41, 99328
    s_nop 0
    buffer_load_dwordx4 v17, s[16:19], s44 offen lds
    s_add_u32 m0, s41, 100352
    s_nop 0
    buffer_load_dwordx4 v18, s[16:19], s44 offen lds
    s_add_u32 m0, s41, 101376
    s_nop 0
    buffer_load_dwordx4 v19, s[16:19], s44 offen lds
    s_add_u32 s44, s44, s42
    s_add_u32 m0, s40, 98304
    s_nop 0
    buffer_load_dwordx4 v8, s[12:15], s43 offen lds
    s_add_u32 m0, s40, 99328
    s_nop 0
    buffer_load_dwordx4 v9, s[12:15], s43 offen lds
    s_add_u32 m0, s40, 100352
    s_nop 0
    buffer_load_dwordx4 v10, s[12:15], s43 offen lds
    s_add_u32 m0, s40, 101376
    s_nop 0
    buffer_load_dwordx4 v11, s[12:15], s43 offen lds
    s_add_u32 m0, s40, 102400
    s_nop 0
    buffer_load_dwordx4 v12, s[12:15], s43 offen lds
    s_add_u32 m0, s40, 103424
    s_nop 0
    buffer_load_dwordx4 v13, s[12:15], s43 offen lds
    s_add_u32 m0, s40, 104448
    s_nop 0
    buffer_load_dwordx4 v14, s[12:15], s43 offen lds
    s_add_u32 m0, s40, 105472
    s_nop 0
    buffer_load_dwordx4 v15, s[12:15], s43 offen lds
    s_add_u32 s43, s43, 128
    s_add_u32 m0, s49, 0
    s_nop 0
    buffer_load_dwordx4 v30, s[8:11], s39 offen lds
    s_add_u32 s39, s39, 10240
    s_add_u32 m0, s49, 1024
    s_nop 0
    buffer_load_dwordx4 v30, s[8:11], s39 offen lds
    s_add_u32 s39, s39, 10240
    s_add_u32 m0, s49, 2048
    s_nop 0
    buffer_load_dwordx4 v30, s[8:11], s39 offen lds
    s_add_u32 s39, s39, 10240
    s_add_u32 m0, s49, 3072
    s_nop 0
    buffer_load_dwordx4 v30, s[8:11], s39 offen lds
    s_add_u32 s39, s39, 10240
    s_setprio 2
    s_bitcmp1_b32 s2, 5
    s_cbranch_scc1 L_k1_kvdone
    s_cmp_lt_u32 s31, 2
    s_cbranch_scc0 L_k1_v
    v_mfma_f32_16x16x32_bf16 v[48:51], v[68:71], v[64:67], 0
    v_mfma_f32_16x16x32_bf16 v[52:55], v[76:79], v[72:75], 0
    v_mfma_f32_16x16x32_bf16 v[48:51], v[84:87], v[80:83], v[48:51]
    v_mfma_f32_16x16x32_bf16 v[52:55], v[92:95], v[88:91], v[52:55]
    v_mfma_f32_16x16x32_bf16 v[48:51], v[100:103], v[96:99], v[48:51]
    v_mfma_f32_16x16x32_bf16 v[52:55], v[108:111], v[104:107], v[52:55]
    v_mfma_f32_16x16x32_bf16 v[48:51], v[116:119], v[112:115], v[48:51]
    v_mfma_f32_16x16x32_bf16 v[52:55], v[124:127], v[120:123], v[52:55]
    v_mfma_f32_16x16x32_bf16 v[48:51], v[132:135], v[128:131], v[48:51]
    v_mfma_f32_16x16x32_bf16 v[52:55], v[140:143], v[136:139], v[52:55]
    v_mfma_f32_16x16x32_bf16 v[48:51], v[148:151], v[144:147], v[48:51]
    v_mfma_f32_16x16x32_bf16 v[52:55], v[156:159], v[152:155], v[52:55]
    v_mfma_f32_16x16x32_bf16 v[48:51], v[164:167], v[160:163], v[48:51]
    v_mfma_f32_16x16x32_bf16 v[52:55], v[172:175], v[168:171], v[52:55]
    v_mfma_f32_16x16x32_bf16 v[48:51], v[180:183], v[176:179], v[48:51]
    v_mfma_f32_16x16x32_bf16 v[52:55], v[188:191], v[184:187], v[52:55]
    v_mfma_f32_16x16x32_bf16 v[48:51], v[196:199], v[192:195], v[48:51]
    v_mfma_f32_16x16x32_bf16 v[52:55], v[204:207], v[200:203], v[52:55]
    v_mfma_f32_16x16x32_bf16 v[48:51], v[212:215], v[208:211], v[48:51]
    v_mfma_f32_16x16x32_bf16 v[52:55], v[220:223], v[216:219], v[52:55]
    s_branch L_k1_j
L_k1_v:
    v_mfma_f32_16x16x32_bf16 v[48:51], v[64:67], v[68:71], 0
    v_mfma_f32_16x16x32_bf16 v[52:55], v[72:75], v[76:79], 0
    v_mfma_f32_16x16x32_bf16 v[48:51], v[80:83], v[84:87], v[48:51]
    v_mfma_f32_16x16x32_bf16 v[52:55], v[88:91], v[92:95], v[52:55]
    v_mfma_f32_16x16x32_bf16 v[48:51], v[96:99], v[100:103], v[48:51]
    v_mfma_f32_16x16x32_bf16 v[52:55], v[104:107], v[108:111], v[52:55]
    v_mfma_f32_16x16x32_bf16 v[48:51], v[112:115], v[116:119], v[48:51]
    v_mfma_f32_16x16x32_bf16 v[52:55], v[120:123], v[124:127], v[52:55]
    v_mfma_f32_16x16x32_bf16 v[48:51], v[128:131], v[132:135], v[48:51]
    v_mfma_f32_16x16x32_bf16 v[52:55], v[136:139], v[140:143], v[52:55]
    v_mfma_f32_16x16x32_bf16 v[48:51], v[144:147], v[148:151], v[48:51]
    v_mfma_f32_16x16x32_bf16 v[52:55], v[152:155], v[156:159], v[52:55]
    v_mfma_f32_16x16x32_bf16 v[48:51], v[160:163], v[164:167], v[48:51]
    v_mfma_f32_16x16x32_bf16 v[52:55], v[168:171], v[172:175], v[52:55]
    v_mfma_f32_16x16x32_bf16 v[48:51], v[176:179], v[180:183], v[48:51]
    v_mfma_f32_16x16x32_bf16 v[52:55], v[184:187], v[188:191], v[52:55]
    v_mfma_f32_16x16x32_bf16 v[48:51], v[192:195], v[196:199], v[48:51]
    v_mfma_f32_16x16x32_bf16 v[52:55], v[200:203], v[204:207], v[52:55]
    v_mfma_f32_16x16x32_bf16 v[48:51], v[208:211], v[212:215], v[48:51]
    v_mfma_f32_16x16x32_bf16 v[52:55], v[216:219], v[220:223], v[52:55]
L_k1_j:
    s_nop 7
    v_add_f32 v48, v48, v52
    v_add_f32 v49, v49, v53
    v_add_f32 v50, v50, v54
    v_add_f32 v51, v51, v55
    v_cvt_pk_bf16_f32 v54, v48, v49
    v_cvt_pk_bf16_f32 v55, v50, v51
    v_cndmask_b32 v54, v58, v54, s[80:81]
    v_cndmask_b32 v55, v59, v55, s[80:81]
    s_mov_b64 exec, s[82:83]
    buffer_store_dwordx2 v[54:55], v57, s[24:27], s88 offen sc1
    s_mov_b64 exec, -1
    s_cmp_lt_u32 s31, 2
    s_cbranch_scc1 L_k1_kvdone
    v_maximum3_f32 v52, |v48|, |v49|, |v50|
    v_maximum3_f32 v52, v52, |v51|, v52
    s_mov_b32 s45, 0x53800000
    v_cmp_nge_f32 vcc, s45, v52
    s_nop 1
    s_and_b64 vcc, vcc, s[80:81]
    s_cselect_b32 s45, 0x7f807f80, 0
    v_mov_b32 v64, s45
    v_mov_b32 v65, s45
    v_mov_b32 v66, s45
    v_mov_b32 v67, s45
    s_mov_b64 exec, 3
    buffer_store_dwordx4 v[64:67], v60, s[24:27], s88 offen sc1
    s_mov_b64 exec, -1
L_k1_kvdone:
    s_setprio 0
    s_cmp_lg_u32 s31, 0
    s_cbranch_scc1 L_k1_nopub
    s_mov_b32 s50, 0x40000
L_k1_clr:
    v_cmp_eq_u32 vcc, 0, v27
    s_nop 4
    s_cbranch_vccz L_k1_clr_go
    s_sub_u32 s50, s50, 1
    s_cbranch_scc1 L_k1_clr_go
    buffer_load_dword v27, v63, s[20:23], 0 offen sc1
    s_waitcnt vmcnt(0)
    s_branch L_k1_clr
L_k1_clr_go:
    s_bitcmp1_b32 s2, 5
    s_cbranch_scc1 L_k1_nopub
    s_waitcnt lgkmcnt(0)
    s_mov_b64 exec, 0xffff
    buffer_store_dwordx2 v[40:41], v26, s[24:27], s87 offen sc1
    s_mov_b64 exec, -1
L_k1_nopub:
    s_waitcnt vmcnt(16)
    s_barrier
    s_add_u32 m0, s41, 0
    s_nop 0
    buffer_load_dwordx4 v16, s[16:19], s44 offen lds
    s_add_u32 m0, s41, 1024
    s_nop 0
    buffer_load_dwordx4 v17, s[16:19], s44 offen lds
    s_add_u32 m0, s41, 2048
    s_nop 0
    buffer_load_dwordx4 v18, s[16:19], s44 offen lds
    s_add_u32 m0, s41, 3072
    s_nop 0
    buffer_load_dwordx4 v19, s[16:19], s44 offen lds
    s_add_u32 s44, s44, s42
    s_add_u32 m0, s40, 0
    s_nop 0
    buffer_load_dwordx4 v8, s[12:15], s43 offen lds
    s_add_u32 m0, s40, 1024
    s_nop 0
    buffer_load_dwordx4 v9, s[12:15], s43 offen lds
    s_add_u32 m0, s40, 2048
    s_nop 0
    buffer_load_dwordx4 v10, s[12:15], s43 offen lds
    s_add_u32 m0, s40, 3072
    s_nop 0
    buffer_load_dwordx4 v11, s[12:15], s43 offen lds
    s_add_u32 m0, s40, 4096
    s_nop 0
    buffer_load_dwordx4 v12, s[12:15], s43 offen lds
    s_add_u32 m0, s40, 5120
    s_nop 0
    buffer_load_dwordx4 v13, s[12:15], s43 offen lds
    s_add_u32 m0, s40, 6144
    s_nop 0
    buffer_load_dwordx4 v14, s[12:15], s43 offen lds
    s_add_u32 m0, s40, 7168
    s_nop 0
    buffer_load_dwordx4 v15, s[12:15], s43 offen lds
    s_add_u32 s43, s43, 128
    s_waitcnt vmcnt(16)
    s_barrier
    s_add_u32 m0, s41, 49152
    s_nop 0
    buffer_load_dwordx4 v16, s[16:19], s44 offen lds
    s_add_u32 m0, s41, 50176
    s_nop 0
    buffer_load_dwordx4 v17, s[16:19], s44 offen lds
    s_add_u32 m0, s41, 51200
    s_nop 0
    buffer_load_dwordx4 v18, s[16:19], s44 offen lds
    s_add_u32 m0, s41, 52224
    s_nop 0
    buffer_load_dwordx4 v19, s[16:19], s44 offen lds
    s_add_u32 s44, s44, s42
    s_add_u32 m0, s40, 49152
    s_nop 0
    buffer_load_dwordx4 v8, s[12:15], s43 offen lds
    s_add_u32 m0, s40, 50176
    s_nop 0
    buffer_load_dwordx4 v9, s[12:15], s43 offen lds
    s_add_u32 m0, s40, 51200
    s_nop 0
    buffer_load_dwordx4 v10, s[12:15], s43 offen lds
    s_add_u32 m0, s40, 52224
    s_nop 0
    buffer_load_dwordx4 v11, s[12:15], s43 offen lds
    s_add_u32 m0, s40, 53248
    s_nop 0
    buffer_load_dwordx4 v12, s[12:15], s43 offen lds
    s_add_u32 m0, s40, 54272
    s_nop 0
    buffer_load_dwordx4 v13, s[12:15], s43 offen lds
    s_add_u32 m0, s40, 55296
    s_nop 0
    buffer_load_dwordx4 v14, s[12:15], s43 offen lds
    s_add_u32 m0, s40, 56320
    s_nop 0
    buffer_load_dwordx4 v15, s[12:15], s43 offen lds
    s_add_u32 s43, s43, 128
    s_waitcnt vmcnt(12)
    s_barrier
    s_add_u32 m0, s41, 98304
    s_nop 0
    buffer_load_dwordx4 v16, s[16:19], s44 offen lds
    s_add_u32 m0, s41, 99328
    s_nop 0
    buffer_load_dwordx4 v17, s[16:19], s44 offen lds
    s_add_u32 m0, s41, 100352
    s_nop 0
    buffer_load_dwordx4 v18, s[16:19], s44 offen lds
    s_add_u32 m0, s41, 101376
    s_nop 0
    buffer_load_dwordx4 v19, s[16:19], s44 offen lds
    s_add_u32 s44, s44, s42
    s_add_u32 m0, s40, 98304
    s_nop 0
    buffer_load_dwordx4 v8, s[12:15], s43 offen lds
    s_add_u32 m0, s40, 99328
    s_nop 0
    buffer_load_dwordx4 v9, s[12:15], s43 offen lds
    s_add_u32 m0, s40, 100352
    s_nop 0
    buffer_load_dwordx4 v10, s[12:15], s43 offen lds
    s_add_u32 m0, s40, 101376
    s_nop 0
    buffer_load_dwordx4 v11, s[12:15], s43 offen lds
    s_add_u32 m0, s40, 102400
    s_nop 0
    buffer_load_dwordx4 v12, s[12:15], s43 offen lds
    s_add_u32 m0, s40, 103424
    s_nop 0
    buffer_load_dwordx4 v13, s[12:15], s43 offen lds
    s_add_u32 m0, s40, 104448
    s_nop 0
    buffer_load_dwordx4 v14, s[12:15], s43 offen lds
    s_add_u32 m0, s40, 105472
    s_nop 0
    buffer_load_dwordx4 v15, s[12:15], s43 offen lds
    s_add_u32 s43, s43, 128
    s_bitcmp1_b32 s2, 5
    s_cbranch_scc1 L_k1_nokva
    s_cmp_lg_u32 s31, 0
    s_cbranch_scc1 L_k1_nokva
    s_lshl_b32 s45, s29, 10
    s_lshl_b32 s46, s3, 2
    s_add_u32 s45, s45, s46
    s_add_u32 s45, s45, 5783552
    v_mov_b32 v21, 1
    s_mov_b64 exec, 1
    buffer_store_dword v21, v20, s[24:27], s45 offen sc1
    s_mov_b64 exec, -1
L_k1_nokva:
    s_waitcnt vmcnt(12)
    s_barrier
    s_add_u32 m0, s41, 0
    s_nop 0
    buffer_load_dwordx4 v16, s[16:19], s44 offen lds
    s_add_u32 m0, s41, 1024
    s_nop 0
    buffer_load_dwordx4 v17, s[16:19], s44 offen lds
    s_add_u32 m0, s41, 2048
    s_nop 0
    buffer_load_dwordx4 v18, s[16:19], s44 offen lds
    s_add_u32 m0, s41, 3072
    s_nop 0
    buffer_load_dwordx4 v19, s[16:19], s44 offen lds
    s_add_u32 s44, s44, s42
    s_add_u32 m0, s40, 0
    s_nop 0
    buffer_load_dwordx4 v8, s[12:15], s43 offen lds
    s_add_u32 m0, s40, 1024
    s_nop 0
    buffer_load_dwordx4 v9, s[12:15], s43 offen lds
    s_add_u32 m0, s40, 2048
    s_nop 0
    buffer_load_dwordx4 v10, s[12:15], s43 offen lds
    s_add_u32 m0, s40, 3072
    s_nop 0
    buffer_load_dwordx4 v11, s[12:15], s43 offen lds
    s_add_u32 m0, s40, 4096
    s_nop 0
    buffer_load_dwordx4 v12, s[12:15], s43 offen lds
    s_add_u32 m0, s40, 5120
    s_nop 0
    buffer_load_dwordx4 v13, s[12:15], s43 offen lds
    s_add_u32 m0, s40, 6144
    s_nop 0
    buffer_load_dwordx4 v14, s[12:15], s43 offen lds
    s_add_u32 m0, s40, 7168
    s_nop 0
    buffer_load_dwordx4 v15, s[12:15], s43 offen lds
    s_add_u32 s43, s43, 128
    s_waitcnt vmcnt(12)
    s_barrier
    buffer_load_dwordx2 v[28:29], v26, s[24:27], s86 offen sc1
    s_add_u32 m0, s41, 49152
    s_nop 0
    buffer_load_dwordx4 v16, s[16:19], s44 offen lds
    ds_read_b64_tr_b16 v[240:241], v32 offset:0
    s_add_u32 m0, s41, 50176
    s_nop 0
    buffer_load_dwordx4 v17, s[16:19], s44 offen lds
    ds_read_b64_tr_b16 v[242:243], v34 offset:0
    s_add_u32 m0, s41, 51200
    s_nop 0
    buffer_load_dwordx4 v18, s[16:19], s44 offen lds
    ds_read_b64_tr_b16 v[244:245], v32 offset:32
    s_add_u32 m0, s41, 52224
    s_nop 0
    buffer_load_dwordx4 v19, s[16:19], s44 offen lds
    s_add_u32 s44, s44, s42
    ds_read_b64_tr_b16 v[246:247], v34 offset:32
    s_add_u32 m0, s40, 49152
    s_nop 0
    buffer_load_dwordx4 v8, s[12:15], s43 offen lds
    ds_read_b64_tr_b16 v[248:249], v32 offset:64
    s_add_u32 m0, s40, 50176
    s_nop 0
    buffer_load_dwordx4 v9, s[12:15], s43 offen lds
    ds_read_b64_tr_b16 v[250:251], v34 offset:64
    s_add_u32 m0, s40, 51200
    s_nop 0
    buffer_load_dwordx4 v10, s[12:15], s43 offen lds
    ds_read_b64_tr_b16 v[252:253], v32 offset:96
    s_add_u32 m0, s40, 52224
    s_nop 0
    buffer_load_dwordx4 v11, s[12:15], s43 offen lds
    ds_read_b64_tr_b16 v[254:255], v34 offset:96
    s_add_u32 m0, s40, 53248
    s_nop 0
    buffer_load_dwordx4 v12, s[12:15], s43 offen lds
    s_add_u32 m0, s40, 54272
    s_nop 0
    buffer_load_dwordx4 v13, s[12:15], s43 offen lds
    s_add_u32 m0, s40, 55296
    s_nop 0
    buffer_load_dwordx4 v14, s[12:15], s43 offen lds
    s_add_u32 m0, s40, 56320
    s_nop 0
    buffer_load_dwordx4 v15, s[12:15], s43 offen lds
    s_add_u32 s43, s43, 128
    s_waitcnt lgkmcnt(0)
    buffer_store_dwordx4 v[240:243], v22, s[24:27], s33 offen offset:0 sc0 sc1
    s_waitcnt lgkmcnt(0)
    buffer_store_dwordx4 v[244:247], v22, s[24:27], s33 offen offset:1024 sc0 sc1
    s_waitcnt vmcnt(14)
    s_barrier
    s_waitcnt lgkmcnt(0)
    buffer_store_dwordx4 v[248:251], v22, s[24:27], s33 offen offset:2048 sc0 sc1
    s_waitcnt lgkmcnt(0)
    buffer_store_dwordx4 v[252:255], v22, s[24:27], s33 offen offset:3072 sc0 sc1
    s_mov_b32 s50, 0x40000
L_k1_rec:
    v_cmp_eq_u32 vcc, 0, v29
    s_nop 4
    s_cbranch_vccz L_k1_rec_go
    s_sub_u32 s50, s50, 1
    s_cbranch_scc1 L_k1_rec_go
    buffer_load_dwordx2 v[28:29], v26, s[24:27], s86 offen sc1
    s_waitcnt vmcnt(0)
    s_branch L_k1_rec
L_k1_rec_go:
    ds_write_b64 v33, v[28:29]
    v_mov_b32 v35, 160000
    ds_write_b32 v35, v20
    ds_write_b32 v35, v20 offset:4
    ds_write_b32 v35, v20 offset:8
    ds_write_b32 v35, v20 offset:12
    s_waitcnt vmcnt(4)
    s_waitcnt lgkmcnt(0)
    s_barrier
    s_barrier
    s_branch L_k2_down
L_k1_stats:
    s_waitcnt vmcnt(0)
    v_lshlrev_b32 v16, 16, v56
    v_and_b32 v17, s42, v56
    v_lshlrev_b32 v18, 16, v57
    v_and_b32 v19, s42, v57
    v_lshlrev_b32 v20, 16, v58
    v_and_b32 v21, s42, v58
    v_lshlrev_b32 v22, 16, v59
    v_and_b32 v23, s42, v59
    v_lshlrev_b32 v24, 16, v60
    v_and_b32 v25, s42, v60
    v_lshlrev_b32 v26, 16, v61
    v_and_b32 v27, s42, v61
    v_lshlrev_b32 v28, 16, v62
    v_and_b32 v29, s42, v62
    v_lshlrev_b32 v30, 16, v63
    v_and_b32 v31, s42, v63
    v_lshlrev_b32 v32, 16, v64
    v_and_b32 v33, s42, v64
    v_lshlrev_b32 v34, 16, v65
    v_and_b32 v35, s42, v65
    v_lshlrev_b32 v36, 16, v66
    v_and_b32 v37, s42, v66
    v_lshlrev_b32 v38, 16, v67
    v_and_b32 v39, s42, v67
    v_lshlrev_b32 v40, 16, v68
    v_and_b32 v41, s42, v68
    v_lshlrev_b32 v42, 16, v69
    v_and_b32 v43, s42, v69
    v_lshlrev_b32 v44, 16, v70
    v_and_b32 v45, s42, v70
    v_lshlrev_b32 v46, 16, v71
    v_and_b32 v47, s42, v71
    v_lshlrev_b32 v48, 16, v72
    v_and_b32 v49, s42, v72
    v_lshlrev_b32 v50, 16, v73
    v_and_b32 v51, s42, v73
    v_lshlrev_b32 v52, 16, v74
    v_and_b32 v53, s42, v74
    v_lshlrev_b32 v54, 16, v75
    v_and_b32 v55, s42, v75
    v_pk_add_f32 v[76:77], v[16:17], v[18:19]
    v_pk_add_f32 v[78:79], v[20:21], v[22:23]
    v_pk_add_f32 v[76:77], v[76:77], v[24:25]
    v_pk_add_f32 v[78:79], v[78:79], v[26:27]
    v_pk_add_f32 v[76:77], v[76:77], v[28:29]
    v_pk_add_f32 v[78:79], v[78:79], v[30:31]
    v_pk_add_f32 v[76:77], v[76:77], v[32:33]
    v_pk_add_f32 v[78:79], v[78:79], v[34:35]
    v_pk_add_f32 v[76:77], v[76:77], v[36:37]
    v_pk_add_f32 v[78:79], v[78:79], v[38:39]
    v_pk_add_f32 v[76:77], v[76:77], v[40:41]
    v_pk_add_f32 v[78:79], v[78:79], v[42:43]
    v_pk_add_f32 v[76:77], v[76:77], v[44:45]
    v_pk_add_f32 v[78:79], v[78:79], v[46:47]
    v_pk_add_f32 v[76:77], v[76:77], v[48:49]
    v_pk_add_f32 v[78:79], v[78:79], v[50:51]
    v_pk_add_f32 v[76:77], v[76:77], v[52:53]
    v_pk_add_f32 v[78:79], v[78:79], v[54:55]
    v_pk_add_f32 v[76:77], v[76:77], v[78:79]
    v_add_f32 v76, v76, v77
    s_nop 1
    v_add_f32_dpp v76, v76, v76 row_ror:8 row_mask:0xf bank_mask:0xf
    s_nop 1
    v_add_f32_dpp v76, v76, v76 row_ror:4 row_mask:0xf bank_mask:0xf
    s_nop 1
    v_add_f32_dpp v76, v76, v76 row_ror:2 row_mask:0xf bank_mask:0xf
    s_nop 1
    v_add_f32_dpp v76, v76, v76 row_ror:1 row_mask:0xf bank_mask:0xf
    v_mul_f32 v76, 0xbacccccd, v76
    v_pk_add_f32 v[60:61], v[16:17], v[76:77] op_sel_hi:[1,0]
    v_pk_add_f32 v[62:63], v[18:19], v[76:77] op_sel_hi:[1,0]
    v_pk_mul_f32 v[56:57], v[60:61], v[60:61]
    v_pk_add_f32 v[60:61], v[20:21], v[76:77] op_sel_hi:[1,0]
    v_pk_mul_f32 v[58:59], v[62:63], v[62:63]
    v_pk_add_f32 v[62:63], v[22:23], v[76:77] op_sel_hi:[1,0]
    v_pk_fma_f32 v[56:57], v[60:61], v[60:61], v[56:57]
    v_pk_add_f32 v[60:61], v[24:25], v[76:77] op_sel_hi:[1,0]
    v_pk_fma_f32 v[58:59], v[62:63], v[62:63], v[58:59]
    v_pk_add_f32 v[62:63], v[26:27], v[76:77] op_sel_hi:[1,0]
    v_pk_fma_f32 v[56:57], v[60:61], v[60:61], v[56:57]
    v_pk_add_f32 v[60:61], v[28:29], v[76:77] op_sel_hi:[1,0]
    v_pk_fma_f32 v[58:59], v[62:63], v[62:63], v[58:59]
    v_pk_add_f32 v[62:63], v[30:31], v[76:77] op_sel_hi:[1,0]
    v_pk_fma_f32 v[56:57], v[60:61], v[60:61], v[56:57]
    v_pk_add_f32 v[60:61], v[32:33], v[76:77] op_sel_hi:[1,0]
    v_pk_fma_f32 v[58:59], v[62:63], v[62:63], v[58:59]
    v_pk_add_f32 v[62:63], v[34:35], v[76:77] op_sel_hi:[1,0]
    v_pk_fma_f32 v[56:57], v[60:61], v[60:61], v[56:57]
    v_pk_add_f32 v[60:61], v[36:37], v[76:77] op_sel_hi:[1,0]
    v_pk_fma_f32 v[58:59], v[62:63], v[62:63], v[58:59]
    v_pk_add_f32 v[62:63], v[38:39], v[76:77] op_sel_hi:[1,0]
    v_pk_fma_f32 v[56:57], v[60:61], v[60:61], v[56:57]
    v_pk_add_f32 v[60:61], v[40:41], v[76:77] op_sel_hi:[1,0]
    v_pk_fma_f32 v[58:59], v[62:63], v[62:63], v[58:59]
    v_pk_add_f32 v[62:63], v[42:43], v[76:77] op_sel_hi:[1,0]
    v_pk_fma_f32 v[56:57], v[60:61], v[60:61], v[56:57]
    v_pk_add_f32 v[60:61], v[44:45], v[76:77] op_sel_hi:[1,0]
    v_pk_fma_f32 v[58:59], v[62:63], v[62:63], v[58:59]
    v_pk_add_f32 v[62:63], v[46:47], v[76:77] op_sel_hi:[1,0]
    v_pk_fma_f32 v[56:57], v[60:61], v[60:61], v[56:57]
    v_pk_add_f32 v[60:61], v[48:49], v[76:77] op_sel_hi:[1,0]
    v_pk_fma_f32 v[58:59], v[62:63], v[62:63], v[58:59]
    v_pk_add_f32 v[62:63], v[50:51], v[76:77] op_sel_hi:[1,0]
    v_pk_fma_f32 v[56:57], v[60:61], v[60:61], v[56:57]
    v_pk_add_f32 v[60:61], v[52:53], v[76:77] op_sel_hi:[1,0]
    v_pk_fma_f32 v[58:59], v[62:63], v[62:63], v[58:59]
    v_pk_add_f32 v[62:63], v[54:55], v[76:77] op_sel_hi:[1,0]
    v_pk_fma_f32 v[56:57], v[60:61], v[60:61], v[56:57]
    v_pk_fma_f32 v[58:59], v[62:63], v[62:63], v[58:59]
    v_pk_add_f32 v[56:57], v[56:57], v[58:59]
    v_add_f32 v56, v56, v57
    s_nop 1
    v_add_f32_dpp v56, v56, v56 row_ror:8 row_mask:0xf bank_mask:0xf
    s_nop 1
    v_add_f32_dpp v56, v56, v56 row_ror:4 row_mask:0xf bank_mask:0xf
    s_nop 1
    v_add_f32_dpp v56, v56, v56 row_ror:2 row_mask:0xf bank_mask:0xf
    s_nop 1
    v_add_f32_dpp v56, v56, v56 row_ror:1 row_mask:0xf bank_mask:0xf
    v_mul_f32 v56, 0x3acccccd, v56
    v_cvt_pk_bf16_f32 v56, v56, v56
    v_cvt_pk_bf16_f32 v78, v76, v76
    v_lshlrev_b32 v56, 16, v56
    v_add_f32 v56, 0x3727c5ac, v56
    v_cvt_pk_bf16_f32 v56, v56, v56
    v_lshlrev_b32 v56, 16, v56
    v_sqrt_f32 v56, v56
    v_lshlrev_b32 v76, 16, v78
    v_cvt_pk_bf16_f32 v56, v56, v56
    v_lshlrev_b32 v56, 16, v56
    v_rcp_f32 v79, v56
    v_pk_add_f32 v[16:17], v[16:17], v[76:77] op_sel_hi:[1,0]
    v_pk_add_f32 v[18:19], v[18:19], v[76:77] op_sel_hi:[1,0]
    v_pk_add_f32 v[20:21], v[20:21], v[76:77] op_sel_hi:[1,0]
    v_pk_add_f32 v[22:23], v[22:23], v[76:77] op_sel_hi:[1,0]
    v_pk_add_f32 v[24:25], v[24:25], v[76:77] op_sel_hi:[1,0]
    v_pk_add_f32 v[26:27], v[26:27], v[76:77] op_sel_hi:[1,0]
    v_pk_add_f32 v[28:29], v[28:29], v[76:77] op_sel_hi:[1,0]
    v_pk_add_f32 v[30:31], v[30:31], v[76:77] op_sel_hi:[1,0]
    v_pk_add_f32 v[32:33], v[32:33], v[76:77] op_sel_hi:[1,0]
    v_pk_add_f32 v[34:35], v[34:35], v[76:77] op_sel_hi:[1,0]
    v_pk_add_f32 v[36:37], v[36:37], v[76:77] op_sel_hi:[1,0]
    v_pk_add_f32 v[38:39], v[38:39], v[76:77] op_sel_hi:[1,0]
    v_pk_add_f32 v[40:41], v[40:41], v[76:77] op_sel_hi:[1,0]
    v_pk_add_f32 v[42:43], v[42:43], v[76:77] op_sel_hi:[1,0]
    v_pk_add_f32 v[44:45], v[44:45], v[76:77] op_sel_hi:[1,0]
    v_pk_add_f32 v[46:47], v[46:47], v[76:77] op_sel_hi:[1,0]
    v_pk_add_f32 v[48:49], v[48:49], v[76:77] op_sel_hi:[1,0]
    v_pk_add_f32 v[50:51], v[50:51], v[76:77] op_sel_hi:[1,0]
    v_pk_add_f32 v[52:53], v[52:53], v[76:77] op_sel_hi:[1,0]
    v_pk_add_f32 v[54:55], v[54:55], v[76:77] op_sel_hi:[1,0]
    v_or_b32 v79, 1, v79
    ds_write_b64 v88, v[78:79]
    v_pk_mul_f32 v[16:17], v[16:17], v[78:79] op_sel:[0,1]
    v_pk_mul_f32 v[18:19], v[18:19], v[78:79] op_sel:[0,1]
    v_pk_mul_f32 v[20:21], v[20:21], v[78:79] op_sel:[0,1]
    v_pk_mul_f32 v[22:23], v[22:23], v[78:79] op_sel:[0,1]
    v_cvt_pk_bf16_f32 v56, v16, v17
    v_cvt_pk_bf16_f32 v57, v18, v19
    v_cvt_pk_bf16_f32 v58, v20, v21
    v_cvt_pk_bf16_f32 v59, v22, v23
    ds_write_b128 v90, v[56:59] offset:0
    v_pk_mul_f32 v[24:25], v[24:25], v[78:79] op_sel:[0,1]
    v_pk_mul_f32 v[26:27], v[26:27], v[78:79] op_sel:[0,1]
    v_pk_mul_f32 v[28:29], v[28:29], v[78:79] op_sel:[0,1]
    v_pk_mul_f32 v[30:31], v[30:31], v[78:79] op_sel:[0,1]
    v_cvt_pk_bf16_f32 v60, v24, v25
    v_cvt_pk_bf16_f32 v61, v26, v27
    v_cvt_pk_bf16_f32 v62, v28, v29
    v_cvt_pk_bf16_f32 v63, v30, v31
    ds_write_b128 v90, v[60:63] offset:256
    v_pk_mul_f32 v[32:33], v[32:33], v[78:79] op_sel:[0,1]
    v_pk_mul_f32 v[34:35], v[34:35], v[78:79] op_sel:[0,1]
    v_pk_mul_f32 v[36:37], v[36:37], v[78:79] op_sel:[0,1]
    v_pk_mul_f32 v[38:39], v[38:39], v[78:79] op_sel:[0,1]
    v_cvt_pk_bf16_f32 v64, v32, v33
    v_cvt_pk_bf16_f32 v65, v34, v35
    v_cvt_pk_bf16_f32 v66, v36, v37
    v_cvt_pk_bf16_f32 v67, v38, v39
    ds_write_b128 v90, v[64:67] offset:512
    v_pk_mul_f32 v[40:41], v[40:41], v[78:79] op_sel:[0,1]
    v_pk_mul_f32 v[42:43], v[42:43], v[78:79] op_sel:[0,1]
    v_pk_mul_f32 v[44:45], v[44:45], v[78:79] op_sel:[0,1]
    v_pk_mul_f32 v[46:47], v[46:47], v[78:79] op_sel:[0,1]
    v_cvt_pk_bf16_f32 v68, v40, v41
    v_cvt_pk_bf16_f32 v69, v42, v43
    v_cvt_pk_bf16_f32 v70, v44, v45
    v_cvt_pk_bf16_f32 v71, v46, v47
    ds_write_b128 v90, v[68:71] offset:768
    v_pk_mul_f32 v[48:49], v[48:49], v[78:79] op_sel:[0,1]
    v_pk_mul_f32 v[50:51], v[50:51], v[78:79] op_sel:[0,1]
    v_pk_mul_f32 v[52:53], v[52:53], v[78:79] op_sel:[0,1]
    v_pk_mul_f32 v[54:55], v[54:55], v[78:79] op_sel:[0,1]
    v_cvt_pk_bf16_f32 v72, v48, v49
    v_cvt_pk_bf16_f32 v73, v50, v51
    v_cvt_pk_bf16_f32 v74, v52, v53
    v_cvt_pk_bf16_f32 v75, v54, v55
    ds_write_b128 v90, v[72:75] offset:1024
    s_waitcnt lgkmcnt(0)
    s_barrier
L_k1_compute:
    s_mov_b32 s24, s6
    s_mov_b32 s25, s7
    s_mov_b32 s26, 0x1400000
    s_mov_b32 s27, 0x20000
    s_xor_b32 s43, s30, 4
    s_add_u32 s43, s43, s28
    s_cmp_lg_u32 s43, 0
    s_cbranch_scc1 L_k1_noclr
    v_mov_b32 v120, 0
    v_mov_b32 v121, 0
    v_mov_b32 v122, 0
    v_mov_b32 v123, 0
    v_lshlrev_b32 v26, 4, v1
    s_lshl_b32 s39, s29, 11
    s_add_u32 s39, s39, 5832704
    buffer_store_dwordx4 v[120:123], v26, s[24:27], s39 offen sc1
    buffer_store_dwordx4 v[120:123], v26, s[24:27], s39 offen offset:1024 sc1
    s_lshl_b32 s39, s29, 10
    s_add_u32 s39, s39, 5767168
    buffer_store_dwordx4 v[120:123], v26, s[24:27], s39 offen sc1
    s_add_u32 s39, s39, 16384
    buffer_store_dwordx4 v[120:123], v26, s[24:27], s39 offen sc1
L_k1_noclr:
    s_and_b32 s34, s28, 1
    s_lshr_b32 s35, s28, 1
    v_mov_b32 v12, v3
    v_lshrrev_b32 v15, 2, v2
    v_lshl_add_u32 v4, v12, 3, v15
    v_lshlrev_b32 v4, 7, v4
    v_bfe_u32 v15, v1, 1, 1
    s_lshl_b32 s36, s34, 2
    v_add_u32 v15, s36, v15
    v_bfe_u32 v16, v1, 3, 2
    v_lshlrev_b32 v16, 1, v16
    v_xor_b32 v15, v15, v16
    v_lshl_add_u32 v4, v15, 4, v4
    v_and_b32 v16, 1, v1
    v_lshl_add_u32 v4, v16, 3, v4
    s_lshl_b32 s36, s35, 12
    s_add_u32 s36, s36, 32768
    v_add_u32 v4, s36, v4
    v_xor_b32 v5, 32, v4
    v_lshrrev_b32 v15, 1, v2
    v_xor_b32 v15, v15, v12
    v_lshlrev_b32 v6, 7, v2
    v_lshl_add_u32 v6, v15, 4, v6
    s_lshl_b32 s36, s35, 14
    v_add_u32 v6, s36, v6
    s_lshl_b32 s36, s35, 6
    v_xor_b32 v6, s36, v6
    v_xor_b32 v7, 64, v6
    v_xor_b32 v8, 0x1000, v4
    v_xor_b32 v9, 0x1000, v5
    v_add_u32 v10, 98304, v4
    v_add_u32 v11, 98304, v5
    v_add_u32 v12, 98304, v6
    v_add_u32 v13, 98304, v7
    v_add_u32 v14, 98304, v8
    v_add_u32 v15, 98304, v9
    v_mov_b64 v[128:129], 0
    v_mov_b64 v[130:131], 0
    v_mov_b64 v[132:133], 0
    v_mov_b64 v[134:135], 0
    v_mov_b64 v[136:137], 0
    v_mov_b64 v[138:139], 0
    v_mov_b64 v[140:141], 0
    v_mov_b64 v[142:143], 0
    v_mov_b64 v[144:145], 0
    v_mov_b64 v[146:147], 0
    v_mov_b64 v[148:149], 0
    v_mov_b64 v[150:151], 0
    v_mov_b64 v[152:153], 0
    v_mov_b64 v[154:155], 0
    v_mov_b64 v[156:157], 0
    v_mov_b64 v[158:159], 0
    v_mov_b64 v[160:161], 0
    v_mov_b64 v[162:163], 0
    v_mov_b64 v[164:165], 0
    v_mov_b64 v[166:167], 0
    v_mov_b64 v[168:169], 0
    v_mov_b64 v[170:171], 0
    v_mov_b64 v[172:173], 0
    v_mov_b64 v[174:175], 0
    v_mov_b64 v[176:177], 0
    v_mov_b64 v[178:179], 0
    v_mov_b64 v[180:181], 0
    v_mov_b64 v[182:183], 0
    v_mov_b64 v[184:185], 0
    v_mov_b64 v[186:187], 0
    v_mov_b64 v[188:189], 0
    v_mov_b64 v[190:191], 0
    v_mov_b64 v[192:193], 0
    v_mov_b64 v[194:195], 0
    v_mov_b64 v[196:197], 0
    v_mov_b64 v[198:199], 0
    v_mov_b64 v[200:201], 0
    v_mov_b64 v[202:203], 0
    v_mov_b64 v[204:205], 0
    v_mov_b64 v[206:207], 0
    v_mov_b64 v[208:209], 0
    v_mov_b64 v[210:211], 0
    v_mov_b64 v[212:213], 0
    v_mov_b64 v[214:215], 0
    v_mov_b64 v[216:217], 0
    v_mov_b64 v[218:219], 0
    v_mov_b64 v[220:221], 0
    v_mov_b64 v[222:223], 0
    v_mov_b64 v[224:225], 0
    v_mov_b64 v[226:227], 0
    v_mov_b64 v[228:229], 0
    v_mov_b64 v[230:231], 0
    v_mov_b64 v[232:233], 0
    v_mov_b64 v[234:235], 0
    v_mov_b64 v[236:237], 0
    v_mov_b64 v[238:239], 0
    v_mov_b64 v[240:241], 0
    v_mov_b64 v[242:243], 0
    v_mov_b64 v[244:245], 0
    v_mov_b64 v[246:247], 0
    v_mov_b64 v[248:249], 0
    v_mov_b64 v[250:251], 0
    v_mov_b64 v[252:253], 0
    v_mov_b64 v[254:255], 0
    s_lshl_b32 s44, s28, 10
    s_add_u32 s44, s44, 0
    v_lshl_add_u32 v96, v1, 4, s44
    v_xor_b32 v97, 0x800, v96
    s_lshl_b32 s44, s35, 10
    s_add_u32 s44, s44, 161792
    v_lshl_add_u32 v98, v2, 3, s44
    v_lshlrev_b32 v99, 4, v1
    s_lshl_b32 s44, s29, 4
    s_lshl_b32 s37, s35, 3
    s_add_u32 s44, s44, s37
    s_mul_i32 s44, s44, 96256
    s_lshl_b32 s45, s34, 10
    s_add_u32 s44, s44, s45
    s_lshl_b32 s37, s30, 11
    s_lshl_b32 s45, s30, 12
    s_add_u32 s45, s45, 4294932480
    s_cmp_lt_u32 s30, 27
    s_cselect_b32 s37, s37, s45
    s_add_u32 s44, s44, s37
    s_add_u32 s44, s44, 6291456
    s_mov_b32 s45, 0x3ea52b5c
    s_mov_b32 s42, 0xffff0000
    v_mov_b32 v81, 0
    v_mov_b32 v83, 0
    v_mov_b32 v85, 0
    v_mov_b32 v87, 0
    v_mov_b32 v89, 0
    v_mov_b32 v91, 0
    v_mov_b32 v93, 0
    v_mov_b32 v95, 0
    v_mov_b32 v113, 0
    v_mov_b32 v115, 0
    v_mov_b32 v117, 0
    v_mov_b32 v119, 0
    v_mov_b32 v124, 0x3f803f80
    v_mov_b32 v125, 0x3f803f80
    v_mov_b32 v126, 0x3f803f80
    v_mov_b64 v[104:105], 0
    v_mov_b64 v[106:107], 0
    v_mov_b64 v[108:109], 0
    v_mov_b64 v[110:111], 0
    v_mov_b64 v[100:101], 0
    v_mov_b64 v[102:103], 0
    v_mov_b64 v[120:121], 0
    v_mov_b64 v[122:123], 0
    s_mov_b32 s20, s4
    s_mov_b32 s21, s5
    s_mov_b32 s22, 0x100
    s_mov_b32 s23, 0x20000
    s_lshl_b32 s36, s29, 5
    v_mov_b32 v78, 1
    v_mov_b32 v79, s36
    s_cmp_lg_u32 s43, 0
    s_waitcnt vmcnt(0)
    s_cbranch_scc1 L_k1_nosig
    s_mov_b64 exec, 1
    buffer_store_dword v78, v79, s[20:23], 0 offen sc1
    s_mov_b64 exec, -1
L_k1_nosig:
    s_lshr_b32 s36, s2, 3
    s_and_b32 s36, s36, 7
    s_xor_b32 s36, s36, 4
    s_add_u32 s36, s36, s28
    s_cmp_lg_u32 s36, 0
    s_cbranch_scc1 L_k1_notouch
    v_lshlrev_b32 v58, 20, v1
    buffer_load_dword v88, v58, s[24:27], 0 offen sc1
    s_mov_b32 s16, s60
    s_mov_b32 s17, s61
    s_mov_b32 s18, 0x21c000
    s_mov_b32 s19, 0x20000
    buffer_load_dword v88, v58, s[16:19], 0 offen sc1
    s_mov_b32 s16, s62
    s_mov_b32 s17, s63
    s_mov_b32 s18, 0xc8000
    s_mov_b32 s19, 0x20000
    buffer_load_dword v88, v58, s[16:19], 0 offen sc1
    s_mov_b32 s16, s56
    s_mov_b32 s17, s57
    s_mov_b32 s18, 0x6400
    s_mov_b32 s19, 0x20000
    buffer_load_dword v88, v58, s[16:19], 0 offen sc1
    s_mov_b32 s16, s58
    s_mov_b32 s17, s59
    s_mov_b32 s18, 0x6400
    s_mov_b32 s19, 0x20000
    buffer_load_dword v88, v58, s[16:19], 0 offen sc1
    s_mov_b32 s16, s4
    s_mov_b32 s17, s5
    s_mov_b32 s18, 0x100
    s_mov_b32 s19, 0x20000
    buffer_load_dword v88, v58, s[16:19], 0 offen sc1
    s_mov_b32 s16, s84
    s_mov_b32 s17, s85
    s_mov_b32 s18, 0x280000
    s_mov_b32 s19, 0x20000
    buffer_load_dword v88, v58, s[16:19], 0 offen sc1
L_k1_notouch:
    s_mov_b32 s41, 2
    v_mov_b32 v127, 0x3f803f80
    v_mov_b64 v[0:1], 0
    v_mov_b64 v[2:3], 0
    s_waitcnt lgkmcnt(0)
    s_barrier
    ds_read_b64_tr_b16 v[16:17], v4 offset:49152
    ds_read_b64_tr_b16 v[18:19], v4 offset:49664
    ds_read_b128 v[48:51], v6 offset:49152
    ds_read_b64_tr_b16 v[20:21], v5 offset:49152
    ds_read_b64_tr_b16 v[22:23], v5 offset:49664
    ds_read_b64_tr_b16 v[24:25], v4 offset:57344
    ds_read_b64_tr_b16 v[26:27], v4 offset:57856
    ds_read_b64_tr_b16 v[28:29], v5 offset:57344
    ds_read_b64_tr_b16 v[30:31], v5 offset:57856
    ds_read_b128 v[52:55], v6 offset:51200
    ds_read_b128 v[56:59], v6 offset:53248
    ds_read_b128 v[60:63], v6 offset:55296
    ds_read_b128 v[64:67], v6 offset:57344
    .p2align 6
L_k1_loop:
    s_waitcnt lgkmcnt(3)
    v_mfma_f32_16x16x32_bf16 v[128:131], v[16:19], v[48:51], v[128:131]
    ds_read_b128 v[68:71], v6 offset:59392
    v_mfma_f32_16x16x32_bf16 v[132:135], v[20:23], v[48:51], v[132:135]
    ds_read_b64_tr_b16 v[32:33], v8 offset:49152
    v_mfma_f32_16x16x32_bf16 v[136:139], v[24:27], v[48:51], v[136:139]
    ds_read_b64_tr_b16 v[34:35], v8 offset:49664
    v_mfma_f32_16x16x32_bf16 v[140:143], v[28:31], v[48:51], v[140:143]
    v_mfma_f32_16x16x32_bf16 v[144:147], v[16:19], v[52:55], v[144:147]
    ds_read_b128 v[72:75], v6 offset:61440
    v_mfma_f32_16x16x32_bf16 v[148:151], v[20:23], v[52:55], v[148:151]
    ds_read_b64_tr_b16 v[36:37], v9 offset:49152
    v_mfma_f32_16x16x32_bf16 v[152:155], v[24:27], v[52:55], v[152:155]
    ds_read_b64_tr_b16 v[38:39], v9 offset:49664
    v_mfma_f32_16x16x32_bf16 v[156:159], v[28:31], v[52:55], v[156:159]
    s_waitcnt lgkmcnt(7)
    v_mfma_f32_16x16x32_bf16 v[160:163], v[16:19], v[56:59], v[160:163]
    ds_read_b128 v[76:79], v6 offset:63488
    v_mfma_f32_16x16x32_bf16 v[164:167], v[20:23], v[56:59], v[164:167]
    ds_read_b64_tr_b16 v[40:41], v8 offset:57344
    v_mfma_f32_16x16x32_bf16 v[168:171], v[24:27], v[56:59], v[168:171]
    ds_read_b64_tr_b16 v[42:43], v8 offset:57856
    v_mfma_f32_16x16x32_bf16 v[172:175], v[28:31], v[56:59], v[172:175]
    v_mfma_f32_16x16x32_bf16 v[176:179], v[16:19], v[60:63], v[176:179]
    ds_read_b128 v[48:51], v7 offset:49152
    v_mfma_f32_16x16x32_bf16 v[180:183], v[20:23], v[60:63], v[180:183]
    ds_read_b64_tr_b16 v[44:45], v9 offset:57344
    v_mfma_f32_16x16x32_bf16 v[184:187], v[24:27], v[60:63], v[184:187]
    ds_read_b64_tr_b16 v[46:47], v9 offset:57856
    v_mfma_f32_16x16x32_bf16 v[188:191], v[28:31], v[60:63], v[188:191]
    s_waitcnt lgkmcnt(11)
    v_mfma_f32_16x16x32_bf16 v[192:195], v[16:19], v[64:67], v[192:195]
    ds_read_b128 v[52:55], v7 offset:51200
    v_mfma_f32_16x16x32_bf16 v[196:199], v[20:23], v[64:67], v[196:199]
    v_mfma_f32_16x16x32_bf16 v[200:203], v[24:27], v[64:67], v[200:203]
    v_mfma_f32_16x16x32_bf16 v[204:207], v[28:31], v[64:67], v[204:207]
    v_mfma_f32_16x16x32_bf16 v[104:107], v[124:127], v[16:19], v[104:107]
    v_mfma_f32_16x16x32_bf16 v[208:211], v[16:19], v[68:71], v[208:211]
    ds_read_b128 v[56:59], v7 offset:53248
    v_mfma_f32_16x16x32_bf16 v[212:215], v[20:23], v[68:71], v[212:215]
    v_mfma_f32_16x16x32_bf16 v[216:219], v[24:27], v[68:71], v[216:219]
    v_mfma_f32_16x16x32_bf16 v[220:223], v[28:31], v[68:71], v[220:223]
    v_mfma_f32_16x16x32_bf16 v[108:111], v[124:127], v[20:23], v[108:111]
    s_waitcnt lgkmcnt(7)
    v_mfma_f32_16x16x32_bf16 v[224:227], v[16:19], v[72:75], v[224:227]
    ds_read_b128 v[60:63], v7 offset:55296
    v_mfma_f32_16x16x32_bf16 v[228:231], v[20:23], v[72:75], v[228:231]
    v_mfma_f32_16x16x32_bf16 v[232:235], v[24:27], v[72:75], v[232:235]
    v_mfma_f32_16x16x32_bf16 v[236:239], v[28:31], v[72:75], v[236:239]
    v_mfma_f32_16x16x32_bf16 v[0:3], v[124:127], v[24:27], v[0:3]
    v_mfma_f32_16x16x32_bf16 v[240:243], v[16:19], v[76:79], v[240:243]
    ds_read_b128 v[64:67], v7 offset:57344
    v_mfma_f32_16x16x32_bf16 v[244:247], v[20:23], v[76:79], v[244:247]
    v_mfma_f32_16x16x32_bf16 v[248:251], v[24:27], v[76:79], v[248:251]
    v_mfma_f32_16x16x32_bf16 v[252:255], v[28:31], v[76:79], v[252:255]
    v_mfma_f32_16x16x32_bf16 v[100:103], v[124:127], v[28:31], v[100:103]
    s_waitcnt lgkmcnt(3)
    v_mfma_f32_16x16x32_bf16 v[128:131], v[32:35], v[48:51], v[128:131]
    ds_read_b128 v[68:71], v7 offset:59392
    v_mfma_f32_16x16x32_bf16 v[132:135], v[36:39], v[48:51], v[132:135]
    v_mfma_f32_16x16x32_bf16 v[136:139], v[40:43], v[48:51], v[136:139]
    v_mfma_f32_16x16x32_bf16 v[140:143], v[44:47], v[48:51], v[140:143]
    v_mfma_f32_16x16x32_bf16 v[144:147], v[32:35], v[52:55], v[144:147]
    ds_read_b128 v[72:75], v7 offset:61440
    v_mfma_f32_16x16x32_bf16 v[148:151], v[36:39], v[52:55], v[148:151]
    v_mfma_f32_16x16x32_bf16 v[152:155], v[40:43], v[52:55], v[152:155]
    v_mfma_f32_16x16x32_bf16 v[156:159], v[44:47], v[52:55], v[156:159]
    s_waitcnt lgkmcnt(3)
    v_mfma_f32_16x16x32_bf16 v[160:163], v[32:35], v[56:59], v[160:163]
    ds_read_b128 v[76:79], v7 offset:63488
    v_mfma_f32_16x16x32_bf16 v[164:167], v[36:39], v[56:59], v[164:167]
    v_mfma_f32_16x16x32_bf16 v[168:171], v[40:43], v[56:59], v[168:171]
    v_mfma_f32_16x16x32_bf16 v[172:175], v[44:47], v[56:59], v[172:175]
    v_mfma_f32_16x16x32_bf16 v[176:179], v[32:35], v[60:63], v[176:179]
    v_mfma_f32_16x16x32_bf16 v[180:183], v[36:39], v[60:63], v[180:183]
    v_mfma_f32_16x16x32_bf16 v[184:187], v[40:43], v[60:63], v[184:187]
    v_mfma_f32_16x16x32_bf16 v[188:191], v[44:47], v[60:63], v[188:191]
    s_waitcnt lgkmcnt(0)
    v_mfma_f32_16x16x32_bf16 v[192:195], v[32:35], v[64:67], v[192:195]
    s_barrier
    ds_read_b64_tr_b16 v[16:17], v10 offset:0
    v_mfma_f32_16x16x32_bf16 v[196:199], v[36:39], v[64:67], v[196:199]
    ds_read_b64_tr_b16 v[18:19], v10 offset:512
    ds_read_b128 v[48:51], v12 offset:0
    v_mfma_f32_16x16x32_bf16 v[200:203], v[40:43], v[64:67], v[200:203]
    ds_read_b64_tr_b16 v[20:21], v11 offset:0
    v_mfma_f32_16x16x32_bf16 v[204:207], v[44:47], v[64:67], v[204:207]
    ds_read_b64_tr_b16 v[22:23], v11 offset:512
    v_mfma_f32_16x16x32_bf16 v[208:211], v[32:35], v[68:71], v[208:211]
    ds_read_b64_tr_b16 v[24:25], v10 offset:8192
    v_mfma_f32_16x16x32_bf16 v[212:215], v[36:39], v[68:71], v[212:215]
    ds_read_b64_tr_b16 v[26:27], v10 offset:8704
    v_mfma_f32_16x16x32_bf16 v[216:219], v[40:43], v[68:71], v[216:219]
    ds_read_b64_tr_b16 v[28:29], v11 offset:8192
    v_mfma_f32_16x16x32_bf16 v[220:223], v[44:47], v[68:71], v[220:223]
    ds_read_b64_tr_b16 v[30:31], v11 offset:8704
    v_mfma_f32_16x16x32_bf16 v[224:227], v[32:35], v[72:75], v[224:227]
    ds_read_b128 v[52:55], v12 offset:2048
    v_mfma_f32_16x16x32_bf16 v[228:231], v[36:39], v[72:75], v[228:231]
    ds_read_b128 v[56:59], v12 offset:4096
    v_mfma_f32_16x16x32_bf16 v[232:235], v[40:43], v[72:75], v[232:235]
    ds_read_b128 v[60:63], v12 offset:6144
    v_mfma_f32_16x16x32_bf16 v[236:239], v[44:47], v[72:75], v[236:239]
    ds_read_b128 v[64:67], v12 offset:8192
    v_mfma_f32_16x16x32_bf16 v[240:243], v[32:35], v[76:79], v[240:243]
    v_mfma_f32_16x16x32_bf16 v[244:247], v[36:39], v[76:79], v[244:247]
    v_mfma_f32_16x16x32_bf16 v[248:251], v[40:43], v[76:79], v[248:251]
    v_mfma_f32_16x16x32_bf16 v[252:255], v[44:47], v[76:79], v[252:255]
    s_waitcnt lgkmcnt(3)
    v_mfma_f32_16x16x32_bf16 v[128:131], v[16:19], v[48:51], v[128:131]
    ds_read_b128 v[68:71], v12 offset:10240
    v_mfma_f32_16x16x32_bf16 v[132:135], v[20:23], v[48:51], v[132:135]
    ds_read_b64_tr_b16 v[32:33], v14 offset:0
    v_mfma_f32_16x16x32_bf16 v[136:139], v[24:27], v[48:51], v[136:139]
    ds_read_b64_tr_b16 v[34:35], v14 offset:512
    v_mfma_f32_16x16x32_bf16 v[140:143], v[28:31], v[48:51], v[140:143]
    v_mfma_f32_16x16x32_bf16 v[144:147], v[16:19], v[52:55], v[144:147]
    ds_read_b128 v[72:75], v12 offset:12288
    v_mfma_f32_16x16x32_bf16 v[148:151], v[20:23], v[52:55], v[148:151]
    ds_read_b64_tr_b16 v[36:37], v15 offset:0
    v_mfma_f32_16x16x32_bf16 v[152:155], v[24:27], v[52:55], v[152:155]
    ds_read_b64_tr_b16 v[38:39], v15 offset:512
    v_mfma_f32_16x16x32_bf16 v[156:159], v[28:31], v[52:55], v[156:159]
    s_waitcnt lgkmcnt(7)
    v_mfma_f32_16x16x32_bf16 v[160:163], v[16:19], v[56:59], v[160:163]
    ds_read_b128 v[76:79], v12 offset:14336
    v_mfma_f32_16x16x32_bf16 v[164:167], v[20:23], v[56:59], v[164:167]
    ds_read_b64_tr_b16 v[40:41], v14 offset:8192
    v_mfma_f32_16x16x32_bf16 v[168:171], v[24:27], v[56:59], v[168:171]
    ds_read_b64_tr_b16 v[42:43], v14 offset:8704
    v_mfma_f32_16x16x32_bf16 v[172:175], v[28:31], v[56:59], v[172:175]
    v_mfma_f32_16x16x32_bf16 v[176:179], v[16:19], v[60:63], v[176:179]
    ds_read_b128 v[48:51], v13 offset:0
    v_mfma_f32_16x16x32_bf16 v[180:183], v[20:23], v[60:63], v[180:183]
    ds_read_b64_tr_b16 v[44:45], v15 offset:8192
    v_mfma_f32_16x16x32_bf16 v[184:187], v[24:27], v[60:63], v[184:187]
    ds_read_b64_tr_b16 v[46:47], v15 offset:8704
    v_mfma_f32_16x16x32_bf16 v[188:191], v[28:31], v[60:63], v[188:191]
    s_waitcnt lgkmcnt(11)
    v_mfma_f32_16x16x32_bf16 v[192:195], v[16:19], v[64:67], v[192:195]
    ds_read_b128 v[52:55], v13 offset:2048
    v_mfma_f32_16x16x32_bf16 v[196:199], v[20:23], v[64:67], v[196:199]
    v_mfma_f32_16x16x32_bf16 v[200:203], v[24:27], v[64:67], v[200:203]
    v_mfma_f32_16x16x32_bf16 v[204:207], v[28:31], v[64:67], v[204:207]
    v_mfma_f32_16x16x32_bf16 v[104:107], v[124:127], v[16:19], v[104:107]
    v_mfma_f32_16x16x32_bf16 v[208:211], v[16:19], v[68:71], v[208:211]
    ds_read_b128 v[56:59], v13 offset:4096
    v_mfma_f32_16x16x32_bf16 v[212:215], v[20:23], v[68:71], v[212:215]
    v_mfma_f32_16x16x32_bf16 v[216:219], v[24:27], v[68:71], v[216:219]
    v_mfma_f32_16x16x32_bf16 v[220:223], v[28:31], v[68:71], v[220:223]
    v_mfma_f32_16x16x32_bf16 v[108:111], v[124:127], v[20:23], v[108:111]
    s_waitcnt lgkmcnt(7)
    v_mfma_f32_16x16x32_bf16 v[224:227], v[16:19], v[72:75], v[224:227]
    ds_read_b128 v[60:63], v13 offset:6144
    v_mfma_f32_16x16x32_bf16 v[228:231], v[20:23], v[72:75], v[228:231]
    v_mfma_f32_16x16x32_bf16 v[232:235], v[24:27], v[72:75], v[232:235]
    v_mfma_f32_16x16x32_bf16 v[236:239], v[28:31], v[72:75], v[236:239]
    v_mfma_f32_16x16x32_bf16 v[0:3], v[124:127], v[24:27], v[0:3]
    v_mfma_f32_16x16x32_bf16 v[240:243], v[16:19], v[76:79], v[240:243]
    ds_read_b128 v[64:67], v13 offset:8192
    v_mfma_f32_16x16x32_bf16 v[244:247], v[20:23], v[76:79], v[244:247]
    v_mfma_f32_16x16x32_bf16 v[248:251], v[24:27], v[76:79], v[248:251]
    v_mfma_f32_16x16x32_bf16 v[252:255], v[28:31], v[76:79], v[252:255]
    v_mfma_f32_16x16x32_bf16 v[100:103], v[124:127], v[28:31], v[100:103]
    s_waitcnt lgkmcnt(3)
    v_mfma_f32_16x16x32_bf16 v[128:131], v[32:35], v[48:51], v[128:131]
    ds_read_b128 v[68:71], v13 offset:10240
    v_mfma_f32_16x16x32_bf16 v[132:135], v[36:39], v[48:51], v[132:135]
    v_mfma_f32_16x16x32_bf16 v[136:139], v[40:43], v[48:51], v[136:139]
    v_mfma_f32_16x16x32_bf16 v[140:143], v[44:47], v[48:51], v[140:143]
    v_mfma_f32_16x16x32_bf16 v[144:147], v[32:35], v[52:55], v[144:147]
    ds_read_b128 v[72:75], v13 offset:12288
    v_mfma_f32_16x16x32_bf16 v[148:151], v[36:39], v[52:55], v[148:151]
    v_mfma_f32_16x16x32_bf16 v[152:155], v[40:43], v[52:55], v[152:155]
    v_mfma_f32_16x16x32_bf16 v[156:159], v[44:47], v[52:55], v[156:159]
    s_waitcnt lgkmcnt(3)
    v_mfma_f32_16x16x32_bf16 v[160:163], v[32:35], v[56:59], v[160:163]
    ds_read_b128 v[76:79], v13 offset:14336
    v_mfma_f32_16x16x32_bf16 v[164:167], v[36:39], v[56:59], v[164:167]
    v_mfma_f32_16x16x32_bf16 v[168:171], v[40:43], v[56:59], v[168:171]
    v_mfma_f32_16x16x32_bf16 v[172:175], v[44:47], v[56:59], v[172:175]
    v_mfma_f32_16x16x32_bf16 v[176:179], v[32:35], v[60:63], v[176:179]
    v_mfma_f32_16x16x32_bf16 v[180:183], v[36:39], v[60:63], v[180:183]
    v_mfma_f32_16x16x32_bf16 v[184:187], v[40:43], v[60:63], v[184:187]
    v_mfma_f32_16x16x32_bf16 v[188:191], v[44:47], v[60:63], v[188:191]
    s_waitcnt lgkmcnt(0)
    v_mfma_f32_16x16x32_bf16 v[192:195], v[32:35], v[64:67], v[192:195]
    s_barrier
    ds_read_b64_tr_b16 v[16:17], v4 offset:0
    v_mfma_f32_16x16x32_bf16 v[196:199], v[36:39], v[64:67], v[196:199]
    ds_read_b64_tr_b16 v[18:19], v4 offset:512
    ds_read_b128 v[48:51], v6 offset:0
    v_mfma_f32_16x16x32_bf16 v[200:203], v[40:43], v[64:67], v[200:203]
    ds_read_b64_tr_b16 v[20:21], v5 offset:0
    v_mfma_f32_16x16x32_bf16 v[204:207], v[44:47], v[64:67], v[204:207]
    ds_read_b64_tr_b16 v[22:23], v5 offset:512
    v_mfma_f32_16x16x32_bf16 v[208:211], v[32:35], v[68:71], v[208:211]
    ds_read_b64_tr_b16 v[24:25], v4 offset:8192
    v_mfma_f32_16x16x32_bf16 v[212:215], v[36:39], v[68:71], v[212:215]
    ds_read_b64_tr_b16 v[26:27], v4 offset:8704
    v_mfma_f32_16x16x32_bf16 v[216:219], v[40:43], v[68:71], v[216:219]
    ds_read_b64_tr_b16 v[28:29], v5 offset:8192
    v_mfma_f32_16x16x32_bf16 v[220:223], v[44:47], v[68:71], v[220:223]
    ds_read_b64_tr_b16 v[30:31], v5 offset:8704
    v_mfma_f32_16x16x32_bf16 v[224:227], v[32:35], v[72:75], v[224:227]
    ds_read_b128 v[52:55], v6 offset:2048
    v_mfma_f32_16x16x32_bf16 v[228:231], v[36:39], v[72:75], v[228:231]
    ds_read_b128 v[56:59], v6 offset:4096
    v_mfma_f32_16x16x32_bf16 v[232:235], v[40:43], v[72:75], v[232:235]
    ds_read_b128 v[60:63], v6 offset:6144
    v_mfma_f32_16x16x32_bf16 v[236:239], v[44:47], v[72:75], v[236:239]
    ds_read_b128 v[64:67], v6 offset:8192
    v_mfma_f32_16x16x32_bf16 v[240:243], v[32:35], v[76:79], v[240:243]
    v_mfma_f32_16x16x32_bf16 v[244:247], v[36:39], v[76:79], v[244:247]
    v_mfma_f32_16x16x32_bf16 v[248:251], v[40:43], v[76:79], v[248:251]
    v_mfma_f32_16x16x32_bf16 v[252:255], v[44:47], v[76:79], v[252:255]
    s_waitcnt lgkmcnt(3)
    v_mfma_f32_16x16x32_bf16 v[128:131], v[16:19], v[48:51], v[128:131]
    ds_read_b128 v[68:71], v6 offset:10240
    v_mfma_f32_16x16x32_bf16 v[132:135], v[20:23], v[48:51], v[132:135]
    ds_read_b64_tr_b16 v[32:33], v8 offset:0
    v_mfma_f32_16x16x32_bf16 v[136:139], v[24:27], v[48:51], v[136:139]
    ds_read_b64_tr_b16 v[34:35], v8 offset:512
    v_mfma_f32_16x16x32_bf16 v[140:143], v[28:31], v[48:51], v[140:143]
    v_mfma_f32_16x16x32_bf16 v[144:147], v[16:19], v[52:55], v[144:147]
    ds_read_b128 v[72:75], v6 offset:12288
    v_mfma_f32_16x16x32_bf16 v[148:151], v[20:23], v[52:55], v[148:151]
    ds_read_b64_tr_b16 v[36:37], v9 offset:0
    v_mfma_f32_16x16x32_bf16 v[152:155], v[24:27], v[52:55], v[152:155]
    ds_read_b64_tr_b16 v[38:39], v9 offset:512
    v_mfma_f32_16x16x32_bf16 v[156:159], v[28:31], v[52:55], v[156:159]
    s_waitcnt lgkmcnt(7)
    v_mfma_f32_16x16x32_bf16 v[160:163], v[16:19], v[56:59], v[160:163]
    ds_read_b128 v[76:79], v6 offset:14336
    v_mfma_f32_16x16x32_bf16 v[164:167], v[20:23], v[56:59], v[164:167]
    ds_read_b64_tr_b16 v[40:41], v8 offset:8192
    v_mfma_f32_16x16x32_bf16 v[168:171], v[24:27], v[56:59], v[168:171]
    ds_read_b64_tr_b16 v[42:43], v8 offset:8704
    v_mfma_f32_16x16x32_bf16 v[172:175], v[28:31], v[56:59], v[172:175]
    v_mfma_f32_16x16x32_bf16 v[176:179], v[16:19], v[60:63], v[176:179]
    ds_read_b128 v[48:51], v7 offset:0
    v_mfma_f32_16x16x32_bf16 v[180:183], v[20:23], v[60:63], v[180:183]
    ds_read_b64_tr_b16 v[44:45], v9 offset:8192
    v_mfma_f32_16x16x32_bf16 v[184:187], v[24:27], v[60:63], v[184:187]
    ds_read_b64_tr_b16 v[46:47], v9 offset:8704
    v_mfma_f32_16x16x32_bf16 v[188:191], v[28:31], v[60:63], v[188:191]
    s_waitcnt lgkmcnt(11)
    v_mfma_f32_16x16x32_bf16 v[192:195], v[16:19], v[64:67], v[192:195]
    ds_read_b128 v[52:55], v7 offset:2048
    v_mfma_f32_16x16x32_bf16 v[196:199], v[20:23], v[64:67], v[196:199]
    v_mfma_f32_16x16x32_bf16 v[200:203], v[24:27], v[64:67], v[200:203]
    v_mfma_f32_16x16x32_bf16 v[204:207], v[28:31], v[64:67], v[204:207]
    v_mfma_f32_16x16x32_bf16 v[104:107], v[124:127], v[16:19], v[104:107]
    v_mfma_f32_16x16x32_bf16 v[208:211], v[16:19], v[68:71], v[208:211]
    ds_read_b128 v[56:59], v7 offset:4096
    v_mfma_f32_16x16x32_bf16 v[212:215], v[20:23], v[68:71], v[212:215]
    v_mfma_f32_16x16x32_bf16 v[216:219], v[24:27], v[68:71], v[216:219]
    v_mfma_f32_16x16x32_bf16 v[220:223], v[28:31], v[68:71], v[220:223]
    v_mfma_f32_16x16x32_bf16 v[108:111], v[124:127], v[20:23], v[108:111]
    s_waitcnt lgkmcnt(7)
    v_mfma_f32_16x16x32_bf16 v[224:227], v[16:19], v[72:75], v[224:227]
    ds_read_b128 v[60:63], v7 offset:6144
    v_mfma_f32_16x16x32_bf16 v[228:231], v[20:23], v[72:75], v[228:231]
    v_mfma_f32_16x16x32_bf16 v[232:235], v[24:27], v[72:75], v[232:235]
    v_mfma_f32_16x16x32_bf16 v[236:239], v[28:31], v[72:75], v[236:239]
    v_mfma_f32_16x16x32_bf16 v[0:3], v[124:127], v[24:27], v[0:3]
    v_mfma_f32_16x16x32_bf16 v[240:243], v[16:19], v[76:79], v[240:243]
    ds_read_b128 v[64:67], v7 offset:8192
    v_mfma_f32_16x16x32_bf16 v[244:247], v[20:23], v[76:79], v[244:247]
    v_mfma_f32_16x16x32_bf16 v[248:251], v[24:27], v[76:79], v[248:251]
    v_mfma_f32_16x16x32_bf16 v[252:255], v[28:31], v[76:79], v[252:255]
    v_mfma_f32_16x16x32_bf16 v[100:103], v[124:127], v[28:31], v[100:103]
    s_waitcnt lgkmcnt(3)
    v_mfma_f32_16x16x32_bf16 v[128:131], v[32:35], v[48:51], v[128:131]
    ds_read_b128 v[68:71], v7 offset:10240
    v_mfma_f32_16x16x32_bf16 v[132:135], v[36:39], v[48:51], v[132:135]
    v_mfma_f32_16x16x32_bf16 v[136:139], v[40:43], v[48:51], v[136:139]
    v_mfma_f32_16x16x32_bf16 v[140:143], v[44:47], v[48:51], v[140:143]
    v_mfma_f32_16x16x32_bf16 v[144:147], v[32:35], v[52:55], v[144:147]
    ds_read_b128 v[72:75], v7 offset:12288
    v_mfma_f32_16x16x32_bf16 v[148:151], v[36:39], v[52:55], v[148:151]
    v_mfma_f32_16x16x32_bf16 v[152:155], v[40:43], v[52:55], v[152:155]
    v_mfma_f32_16x16x32_bf16 v[156:159], v[44:47], v[52:55], v[156:159]
    s_waitcnt lgkmcnt(3)
    v_mfma_f32_16x16x32_bf16 v[160:163], v[32:35], v[56:59], v[160:163]
    ds_read_b128 v[76:79], v7 offset:14336
    v_mfma_f32_16x16x32_bf16 v[164:167], v[36:39], v[56:59], v[164:167]
    v_mfma_f32_16x16x32_bf16 v[168:171], v[40:43], v[56:59], v[168:171]
    v_mfma_f32_16x16x32_bf16 v[172:175], v[44:47], v[56:59], v[172:175]
    v_mfma_f32_16x16x32_bf16 v[176:179], v[32:35], v[60:63], v[176:179]
    v_mfma_f32_16x16x32_bf16 v[180:183], v[36:39], v[60:63], v[180:183]
    v_mfma_f32_16x16x32_bf16 v[184:187], v[40:43], v[60:63], v[184:187]
    v_mfma_f32_16x16x32_bf16 v[188:191], v[44:47], v[60:63], v[188:191]
    s_waitcnt lgkmcnt(0)
    v_mfma_f32_16x16x32_bf16 v[192:195], v[32:35], v[64:67], v[192:195]
    s_barrier
    ds_read_b64_tr_b16 v[16:17], v4 offset:49152
    v_mfma_f32_16x16x32_bf16 v[196:199], v[36:39], v[64:67], v[196:199]
    ds_read_b64_tr_b16 v[18:19], v4 offset:49664
    ds_read_b128 v[48:51], v6 offset:49152
    v_mfma_f32_16x16x32_bf16 v[200:203], v[40:43], v[64:67], v[200:203]
    ds_read_b64_tr_b16 v[20:21], v5 offset:49152
    s_sub_u32 s41, s41, 1
    v_mfma_f32_16x16x32_bf16 v[204:207], v[44:47], v[64:67], v[204:207]
    ds_read_b64_tr_b16 v[22:23], v5 offset:49664
    v_mfma_f32_16x16x32_bf16 v[208:211], v[32:35], v[68:71], v[208:211]
    ds_read_b64_tr_b16 v[24:25], v4 offset:57344
    v_mfma_f32_16x16x32_bf16 v[212:215], v[36:39], v[68:71], v[212:215]
    ds_read_b64_tr_b16 v[26:27], v4 offset:57856
    v_mfma_f32_16x16x32_bf16 v[216:219], v[40:43], v[68:71], v[216:219]
    ds_read_b64_tr_b16 v[28:29], v5 offset:57344
    v_mfma_f32_16x16x32_bf16 v[220:223], v[44:47], v[68:71], v[220:223]
    ds_read_b64_tr_b16 v[30:31], v5 offset:57856
    v_mfma_f32_16x16x32_bf16 v[224:227], v[32:35], v[72:75], v[224:227]
    ds_read_b128 v[52:55], v6 offset:51200
    v_mfma_f32_16x16x32_bf16 v[228:231], v[36:39], v[72:75], v[228:231]
    ds_read_b128 v[56:59], v6 offset:53248
    v_mfma_f32_16x16x32_bf16 v[232:235], v[40:43], v[72:75], v[232:235]
    ds_read_b128 v[60:63], v6 offset:55296
    v_mfma_f32_16x16x32_bf16 v[236:239], v[44:47], v[72:75], v[236:239]
    ds_read_b128 v[64:67], v6 offset:57344
    v_mfma_f32_16x16x32_bf16 v[240:243], v[32:35], v[76:79], v[240:243]
    v_mfma_f32_16x16x32_bf16 v[244:247], v[36:39], v[76:79], v[244:247]
    v_mfma_f32_16x16x32_bf16 v[248:251], v[40:43], v[76:79], v[248:251]
    v_mfma_f32_16x16x32_bf16 v[252:255], v[44:47], v[76:79], v[252:255]
    s_cbranch_scc0 L_k1_loop
    s_cmp_lt_u32 s30, 27
    s_cbranch_scc1 L_k1_epq
    s_waitcnt lgkmcnt(10)
    v_mfma_f32_16x16x32_bf16 v[128:131], v[16:19], v[48:51], v[128:131]
    ds_read_b64_tr_b16 v[32:33], v8 offset:49152
    ds_read_b64_tr_b16 v[34:35], v8 offset:49664
    s_waitcnt lgkmcnt(10)
    v_mfma_f32_16x16x32_bf16 v[132:135], v[20:23], v[48:51], v[132:135]
    ds_read_b128 v[76:79], v7 offset:49152
    ds_read_b64_tr_b16 v[36:37], v9 offset:49152
    s_waitcnt lgkmcnt(10)
    v_mfma_f32_16x16x32_bf16 v[136:139], v[24:27], v[48:51], v[136:139]
    ds_read_b64_tr_b16 v[38:39], v9 offset:49664
    ds_read_b64_tr_b16 v[40:41], v8 offset:57344
    s_waitcnt lgkmcnt(10)
    v_mfma_f32_16x16x32_bf16 v[140:143], v[28:31], v[48:51], v[140:143]
    ds_read_b64_tr_b16 v[42:43], v8 offset:57856
    ds_read_b64_tr_b16 v[44:45], v9 offset:57344
    v_mfma_f32_16x16x32_bf16 v[104:107], v[124:127], v[16:19], v[104:107]
    ds_read_b64_tr_b16 v[46:47], v9 offset:57856
    ds_read_b128 v[48:51], v7 offset:51200
    v_mfma_f32_16x16x32_bf16 v[108:111], v[124:127], v[20:23], v[108:111]
    ds_read_b32 v80, v98 offset:0
    ds_read_b32 v82, v98 offset:128
    v_mfma_f32_16x16x32_bf16 v[0:3], v[124:127], v[24:27], v[0:3]
    ds_read_b32 v84, v98 offset:256
    ds_read_b32 v86, v98 offset:384
    v_mfma_f32_16x16x32_bf16 v[100:103], v[124:127], v[28:31], v[100:103]
    ds_read_b32 v88, v98 offset:512
    ds_read_b32 v90, v98 offset:640
    s_waitcnt lgkmcnt(15)
    v_mfma_f32_16x16x32_bf16 v[144:147], v[16:19], v[52:55], v[144:147]
    ds_read_b32 v92, v98 offset:768
    ds_read_b32 v94, v98 offset:896
    v_mfma_f32_16x16x32_bf16 v[148:151], v[20:23], v[52:55], v[148:151]
    v_mfma_f32_16x16x32_bf16 v[152:155], v[24:27], v[52:55], v[152:155]
    v_fmac_f32 v120, 0x3e800000, v104
    v_fmac_f32 v121, 0x3e800000, v108
    v_mfma_f32_16x16x32_bf16 v[156:159], v[28:31], v[52:55], v[156:159]
    v_fmac_f32 v122, 0x3e800000, v0
    v_fmac_f32 v123, 0x3e800000, v100
    v_mfma_f32_16x16x32_bf16 v[160:163], v[16:19], v[56:59], v[160:163]
    ds_write_b128 v96, v[120:123]
    ds_read_b128 v[52:55], v7 offset:53248
    v_mfma_f32_16x16x32_bf16 v[164:167], v[20:23], v[56:59], v[164:167]
    ds_read_b128 v[68:71], v6 offset:59392
    ds_read_b128 v[72:75], v7 offset:55296
    v_mfma_f32_16x16x32_bf16 v[168:171], v[24:27], v[56:59], v[168:171]
    s_waitcnt lgkmcnt(0)
    s_barrier
    v_mfma_f32_16x16x32_bf16 v[172:175], v[28:31], v[56:59], v[172:175]
    ds_read_b128 v[0:3], v97
    ds_read2_b32 v[104:105], v98 offset0:1 offset1:33
    v_mfma_f32_16x16x32_bf16 v[128:131], v[32:35], v[76:79], v[128:131]
    ds_read2_b32 v[106:107], v98 offset0:65 offset1:97
    ds_read2_b32 v[108:109], v98 offset0:129 offset1:161
    v_mfma_f32_16x16x32_bf16 v[132:135], v[36:39], v[76:79], v[132:135]
    ds_read2_b32 v[110:111], v98 offset0:193 offset1:225
    ds_read_b128 v[56:59], v6 offset:61440
    v_mfma_f32_16x16x32_bf16 v[136:139], v[40:43], v[76:79], v[136:139]
    v_mfma_f32_16x16x32_bf16 v[140:143], v[44:47], v[76:79], v[140:143]
    s_waitcnt lgkmcnt(5)
    v_add_f32 v0, v0, v120
    v_add_f32 v1, v1, v121
    v_mfma_f32_16x16x32_bf16 v[176:179], v[16:19], v[60:63], v[176:179]
    v_add_f32 v2, v2, v122
    v_add_f32 v3, v3, v123
    v_mfma_f32_16x16x32_bf16 v[180:183], v[20:23], v[60:63], v[180:183]
    v_and_b32 v120, s42, v0
    v_and_b32 v121, s42, v1
    v_mfma_f32_16x16x32_bf16 v[184:187], v[24:27], v[60:63], v[184:187]
    v_and_b32 v122, s42, v2
    v_and_b32 v123, s42, v3
    v_mfma_f32_16x16x32_bf16 v[188:191], v[28:31], v[60:63], v[188:191]
    v_sub_f32 v0, v0, v120
    v_sub_f32 v1, v1, v121
    v_mfma_f32_16x16x32_bf16 v[144:147], v[32:35], v[48:51], v[144:147]
    v_sub_f32 v2, v2, v122
    v_sub_f32 v3, v3, v123
    v_mfma_f32_16x16x32_bf16 v[148:151], v[36:39], v[48:51], v[148:151]
    v_cvt_pk_bf16_f32 v112, v120, v0
    v_cvt_pk_bf16_f32 v114, v121, v1
    v_mfma_f32_16x16x32_bf16 v[152:155], v[40:43], v[48:51], v[152:155]
    v_cvt_pk_bf16_f32 v116, v122, v2
    v_cvt_pk_bf16_f32 v118, v123, v3
    v_mfma_f32_16x16x32_bf16 v[156:159], v[44:47], v[48:51], v[156:159]
    s_waitcnt lgkmcnt(4)
    v_mul_f32 v104, s45, v104
    v_mul_f32 v105, s45, v105
    v_mfma_f32_16x16x16_bf16 v[128:131], v[112:113], v[80:81], v[128:131]
    s_waitcnt lgkmcnt(3)
    v_mul_f32 v106, s45, v106
    v_mul_f32 v107, s45, v107
    v_mfma_f32_16x16x16_bf16 v[132:135], v[114:115], v[80:81], v[132:135]
    s_waitcnt lgkmcnt(2)
    v_mul_f32 v108, s45, v108
    v_mul_f32 v109, s45, v109
    v_mfma_f32_16x16x16_bf16 v[136:139], v[116:117], v[80:81], v[136:139]
    s_waitcnt lgkmcnt(1)
    v_mul_f32 v110, s45, v110
    v_mul_f32 v111, s45, v111
    v_mfma_f32_16x16x16_bf16 v[140:143], v[118:119], v[80:81], v[140:143]
    ds_read_b128 v[76:79], v7 offset:57344
    ds_read_b128 v[60:63], v6 offset:63488
    v_mfma_f32_16x16x32_bf16 v[192:195], v[16:19], v[64:67], v[192:195]
    ds_read_b128 v[48:51], v7 offset:59392
    v_mfma_f32_16x16x32_bf16 v[196:199], v[20:23], v[64:67], v[196:199]
    v_mfma_f32_16x16x32_bf16 v[200:203], v[24:27], v[64:67], v[200:203]
    v_mul_f32 v128, v128, v104
    v_mul_f32 v129, v129, v104
    v_mfma_f32_16x16x32_bf16 v[204:207], v[28:31], v[64:67], v[204:207]
    ds_read_b128 v[64:67], v7 offset:61440
    v_mul_f32 v130, v130, v104
    v_mfma_f32_16x16x32_bf16 v[160:163], v[32:35], v[52:55], v[160:163]
    v_mul_f32 v131, v131, v104
    v_mul_f32 v132, v132, v104
    v_mfma_f32_16x16x32_bf16 v[164:167], v[36:39], v[52:55], v[164:167]
    v_mul_f32 v133, v133, v104
    v_mul_f32 v134, v134, v104
    v_mfma_f32_16x16x32_bf16 v[168:171], v[40:43], v[52:55], v[168:171]
    v_mul_f32 v135, v135, v104
    v_mul_f32 v136, v136, v104
    v_mfma_f32_16x16x32_bf16 v[172:175], v[44:47], v[52:55], v[172:175]
    ds_read_b128 v[52:55], v7 offset:63488
    v_mul_f32 v137, v137, v104
    v_mfma_f32_16x16x16_bf16 v[144:147], v[112:113], v[82:83], v[144:147]
    v_mul_f32 v138, v138, v104
    v_mul_f32 v139, v139, v104
    v_mfma_f32_16x16x16_bf16 v[148:151], v[114:115], v[82:83], v[148:151]
    v_mul_f32 v140, v140, v104
    v_mul_f32 v141, v141, v104
    v_mfma_f32_16x16x16_bf16 v[152:155], v[116:117], v[82:83], v[152:155]
    v_mul_f32 v142, v142, v104
    v_mul_f32 v143, v143, v104
    v_mfma_f32_16x16x16_bf16 v[156:159], v[118:119], v[82:83], v[156:159]
    v_cvt_pk_bf16_f32 v128, v128, v129
    v_cvt_pk_bf16_f32 v129, v130, v131
    v_mfma_f32_16x16x32_bf16 v[208:211], v[16:19], v[68:71], v[208:211]
    v_cvt_pk_bf16_f32 v130, v132, v133
    v_cvt_pk_bf16_f32 v131, v134, v135
    v_mfma_f32_16x16x32_bf16 v[212:215], v[20:23], v[68:71], v[212:215]
    v_cvt_pk_bf16_f32 v132, v136, v137
    v_cvt_pk_bf16_f32 v133, v138, v139
    v_mfma_f32_16x16x32_bf16 v[216:219], v[24:27], v[68:71], v[216:219]
    v_cvt_pk_bf16_f32 v134, v140, v141
    v_cvt_pk_bf16_f32 v135, v142, v143
    v_mfma_f32_16x16x32_bf16 v[220:223], v[28:31], v[68:71], v[220:223]
    buffer_store_dwordx4 v[128:131], v99, s[24:27], s44 offen sc0 sc1
    buffer_store_dwordx4 v[132:135], v99, s[24:27], s44 offen offset:2048 sc0 sc1
    v_mfma_f32_16x16x32_bf16 v[176:179], v[32:35], v[72:75], v[176:179]
    s_add_u32 s44, s44, 96256
    v_mul_f32 v144, v144, v105
    v_mfma_f32_16x16x32_bf16 v[180:183], v[36:39], v[72:75], v[180:183]
    v_mul_f32 v145, v145, v105
    v_mul_f32 v146, v146, v105
    v_mfma_f32_16x16x32_bf16 v[184:187], v[40:43], v[72:75], v[184:187]
    v_mul_f32 v147, v147, v105
    v_mul_f32 v148, v148, v105
    v_mfma_f32_16x16x32_bf16 v[188:191], v[44:47], v[72:75], v[188:191]
    v_mul_f32 v149, v149, v105
    v_mul_f32 v150, v150, v105
    v_mfma_f32_16x16x16_bf16 v[160:163], v[112:113], v[84:85], v[160:163]
    v_mul_f32 v151, v151, v105
    v_mul_f32 v152, v152, v105
    v_mfma_f32_16x16x16_bf16 v[164:167], v[114:115], v[84:85], v[164:167]
    v_mul_f32 v153, v153, v105
    v_mul_f32 v154, v154, v105
    v_mfma_f32_16x16x16_bf16 v[168:171], v[116:117], v[84:85], v[168:171]
    v_mul_f32 v155, v155, v105
    v_mul_f32 v156, v156, v105
    v_mfma_f32_16x16x16_bf16 v[172:175], v[118:119], v[84:85], v[172:175]
    v_mul_f32 v157, v157, v105
    v_mul_f32 v158, v158, v105
    s_waitcnt lgkmcnt(5)
    v_mfma_f32_16x16x32_bf16 v[224:227], v[16:19], v[56:59], v[224:227]
    v_mul_f32 v159, v159, v105
    v_cvt_pk_bf16_f32 v144, v144, v145
    v_mfma_f32_16x16x32_bf16 v[228:231], v[20:23], v[56:59], v[228:231]
    v_cvt_pk_bf16_f32 v145, v146, v147
    v_cvt_pk_bf16_f32 v146, v148, v149
    v_mfma_f32_16x16x32_bf16 v[232:235], v[24:27], v[56:59], v[232:235]
    v_cvt_pk_bf16_f32 v147, v150, v151
    v_cvt_pk_bf16_f32 v148, v152, v153
    v_mfma_f32_16x16x32_bf16 v[236:239], v[28:31], v[56:59], v[236:239]
    v_cvt_pk_bf16_f32 v149, v154, v155
    v_cvt_pk_bf16_f32 v150, v156, v157
    s_waitcnt lgkmcnt(4)
    v_mfma_f32_16x16x32_bf16 v[192:195], v[32:35], v[76:79], v[192:195]
    v_cvt_pk_bf16_f32 v151, v158, v159
    buffer_store_dwordx4 v[144:147], v99, s[24:27], s44 offen sc0 sc1
    v_mfma_f32_16x16x32_bf16 v[196:199], v[36:39], v[76:79], v[196:199]
    buffer_store_dwordx4 v[148:151], v99, s[24:27], s44 offen offset:2048 sc0 sc1
    s_add_u32 s44, s44, 96256
    v_mfma_f32_16x16x32_bf16 v[200:203], v[40:43], v[76:79], v[200:203]
    v_mul_f32 v160, v160, v106
    v_mul_f32 v161, v161, v106
    v_mfma_f32_16x16x32_bf16 v[204:207], v[44:47], v[76:79], v[204:207]
    v_mul_f32 v162, v162, v106
    v_mul_f32 v163, v163, v106
    v_mfma_f32_16x16x16_bf16 v[176:179], v[112:113], v[86:87], v[176:179]
    v_mul_f32 v164, v164, v106
    v_mul_f32 v165, v165, v106
    v_mfma_f32_16x16x16_bf16 v[180:183], v[114:115], v[86:87], v[180:183]
    v_mul_f32 v166, v166, v106
    v_mul_f32 v167, v167, v106
    v_mfma_f32_16x16x16_bf16 v[184:187], v[116:117], v[86:87], v[184:187]
    v_mul_f32 v168, v168, v106
    v_mul_f32 v169, v169, v106
    v_mfma_f32_16x16x16_bf16 v[188:191], v[118:119], v[86:87], v[188:191]
    v_mul_f32 v170, v170, v106
    v_mul_f32 v171, v171, v106
    s_waitcnt lgkmcnt(3)
    v_mfma_f32_16x16x32_bf16 v[240:243], v[16:19], v[60:63], v[240:243]
    v_mul_f32 v172, v172, v106
    v_mul_f32 v173, v173, v106
    v_mfma_f32_16x16x32_bf16 v[244:247], v[20:23], v[60:63], v[244:247]
    v_mul_f32 v174, v174, v106
    v_mul_f32 v175, v175, v106
    v_mfma_f32_16x16x32_bf16 v[248:251], v[24:27], v[60:63], v[248:251]
    v_cvt_pk_bf16_f32 v160, v160, v161
    v_cvt_pk_bf16_f32 v161, v162, v163
    v_mfma_f32_16x16x32_bf16 v[252:255], v[28:31], v[60:63], v[252:255]
    v_cvt_pk_bf16_f32 v162, v164, v165
    v_cvt_pk_bf16_f32 v163, v166, v167
    s_waitcnt lgkmcnt(2)
    v_mfma_f32_16x16x32_bf16 v[208:211], v[32:35], v[48:51], v[208:211]
    v_cvt_pk_bf16_f32 v164, v168, v169
    v_cvt_pk_bf16_f32 v165, v170, v171
    v_mfma_f32_16x16x32_bf16 v[212:215], v[36:39], v[48:51], v[212:215]
    v_cvt_pk_bf16_f32 v166, v172, v173
    v_cvt_pk_bf16_f32 v167, v174, v175
    v_mfma_f32_16x16x32_bf16 v[216:219], v[40:43], v[48:51], v[216:219]
    buffer_store_dwordx4 v[160:163], v99, s[24:27], s44 offen sc0 sc1
    buffer_store_dwordx4 v[164:167], v99, s[24:27], s44 offen offset:2048 sc0 sc1
    v_mfma_f32_16x16x32_bf16 v[220:223], v[44:47], v[48:51], v[220:223]
    s_add_u32 s44, s44, 96256
    v_mul_f32 v176, v176, v107
    v_mfma_f32_16x16x16_bf16 v[192:195], v[112:113], v[88:89], v[192:195]
    v_mul_f32 v177, v177, v107
    v_mul_f32 v178, v178, v107
    v_mfma_f32_16x16x16_bf16 v[196:199], v[114:115], v[88:89], v[196:199]
    v_mul_f32 v179, v179, v107
    v_mul_f32 v180, v180, v107
    v_mfma_f32_16x16x16_bf16 v[200:203], v[116:117], v[88:89], v[200:203]
    v_mul_f32 v181, v181, v107
    v_mul_f32 v182, v182, v107
    v_mfma_f32_16x16x16_bf16 v[204:207], v[118:119], v[88:89], v[204:207]
    v_mul_f32 v183, v183, v107
    v_mul_f32 v184, v184, v107
    s_waitcnt lgkmcnt(1)
    v_mfma_f32_16x16x32_bf16 v[224:227], v[32:35], v[64:67], v[224:227]
    v_mul_f32 v185, v185, v107
    v_mul_f32 v186, v186, v107
    v_mfma_f32_16x16x32_bf16 v[228:231], v[36:39], v[64:67], v[228:231]
    v_mul_f32 v187, v187, v107
    v_mul_f32 v188, v188, v107
    v_mfma_f32_16x16x32_bf16 v[232:235], v[40:43], v[64:67], v[232:235]
    v_mul_f32 v189, v189, v107
    v_mul_f32 v190, v190, v107
    v_mfma_f32_16x16x32_bf16 v[236:239], v[44:47], v[64:67], v[236:239]
    v_mul_f32 v191, v191, v107
    v_cvt_pk_bf16_f32 v176, v176, v177
    v_mfma_f32_16x16x16_bf16 v[208:211], v[112:113], v[90:91], v[208:211]
    v_cvt_pk_bf16_f32 v177, v178, v179
    v_cvt_pk_bf16_f32 v178, v180, v181
    v_mfma_f32_16x16x16_bf16 v[212:215], v[114:115], v[90:91], v[212:215]
    v_cvt_pk_bf16_f32 v179, v182, v183
    v_cvt_pk_bf16_f32 v180, v184, v185
    v_mfma_f32_16x16x16_bf16 v[216:219], v[116:117], v[90:91], v[216:219]
    v_cvt_pk_bf16_f32 v181, v186, v187
    v_cvt_pk_bf16_f32 v182, v188, v189
    v_mfma_f32_16x16x16_bf16 v[220:223], v[118:119], v[90:91], v[220:223]
    v_cvt_pk_bf16_f32 v183, v190, v191
    buffer_store_dwordx4 v[176:179], v99, s[24:27], s44 offen sc0 sc1
    s_waitcnt lgkmcnt(0)
    v_mfma_f32_16x16x32_bf16 v[240:243], v[32:35], v[52:55], v[240:243]
    buffer_store_dwordx4 v[180:183], v99, s[24:27], s44 offen offset:2048 sc0 sc1
    s_add_u32 s44, s44, 96256
    v_mfma_f32_16x16x32_bf16 v[244:247], v[36:39], v[52:55], v[244:247]
    v_mul_f32 v192, v192, v108
    v_mul_f32 v193, v193, v108
    v_mfma_f32_16x16x32_bf16 v[248:251], v[40:43], v[52:55], v[248:251]
    v_mul_f32 v194, v194, v108
    v_mul_f32 v195, v195, v108
    v_mfma_f32_16x16x32_bf16 v[252:255], v[44:47], v[52:55], v[252:255]
    v_mul_f32 v196, v196, v108
    v_mul_f32 v197, v197, v108
    v_mfma_f32_16x16x16_bf16 v[224:227], v[112:113], v[92:93], v[224:227]
    v_mul_f32 v198, v198, v108
    v_mul_f32 v199, v199, v108
    v_mfma_f32_16x16x16_bf16 v[228:231], v[114:115], v[92:93], v[228:231]
    v_mul_f32 v200, v200, v108
    v_mul_f32 v201, v201, v108
    v_mfma_f32_16x16x16_bf16 v[232:235], v[116:117], v[92:93], v[232:235]
    v_mul_f32 v202, v202, v108
    v_mul_f32 v203, v203, v108
    v_mfma_f32_16x16x16_bf16 v[236:239], v[118:119], v[92:93], v[236:239]
    v_mul_f32 v204, v204, v108
    v_mul_f32 v205, v205, v108
    v_mfma_f32_16x16x16_bf16 v[240:243], v[112:113], v[94:95], v[240:243]
    v_mul_f32 v206, v206, v108
    v_mul_f32 v207, v207, v108
    v_mfma_f32_16x16x16_bf16 v[244:247], v[114:115], v[94:95], v[244:247]
    v_cvt_pk_bf16_f32 v192, v192, v193
    v_cvt_pk_bf16_f32 v193, v194, v195
    v_mfma_f32_16x16x16_bf16 v[248:251], v[116:117], v[94:95], v[248:251]
    v_cvt_pk_bf16_f32 v194, v196, v197
    v_cvt_pk_bf16_f32 v195, v198, v199
    v_mfma_f32_16x16x16_bf16 v[252:255], v[118:119], v[94:95], v[252:255]
    v_cvt_pk_bf16_f32 v196, v200, v201
    v_cvt_pk_bf16_f32 v197, v202, v203
    v_cvt_pk_bf16_f32 v198, v204, v205
    v_cvt_pk_bf16_f32 v199, v206, v207
    buffer_store_dwordx4 v[192:195], v99, s[24:27], s44 offen sc0 sc1
    buffer_store_dwordx4 v[196:199], v99, s[24:27], s44 offen offset:2048 sc0 sc1
    s_add_u32 s44, s44, 96256
    v_mul_f32 v208, v208, v109
    v_mul_f32 v209, v209, v109
    v_mul_f32 v210, v210, v109
    v_mul_f32 v211, v211, v109
    v_mul_f32 v212, v212, v109
    v_mul_f32 v213, v213, v109
    v_mul_f32 v214, v214, v109
    v_mul_f32 v215, v215, v109
    v_mul_f32 v216, v216, v109
    v_mul_f32 v217, v217, v109
    v_mul_f32 v218, v218, v109
    v_mul_f32 v219, v219, v109
    v_mul_f32 v220, v220, v109
    v_mul_f32 v221, v221, v109
    v_mul_f32 v222, v222, v109
    v_mul_f32 v223, v223, v109
    v_cvt_pk_bf16_f32 v208, v208, v209
    v_cvt_pk_bf16_f32 v209, v210, v211
    v_cvt_pk_bf16_f32 v210, v212, v213
    v_cvt_pk_bf16_f32 v211, v214, v215
    v_cvt_pk_bf16_f32 v212, v216, v217
    v_cvt_pk_bf16_f32 v213, v218, v219
    v_cvt_pk_bf16_f32 v214, v220, v221
    v_cvt_pk_bf16_f32 v215, v222, v223
    buffer_store_dwordx4 v[208:211], v99, s[24:27], s44 offen sc0 sc1
    buffer_store_dwordx4 v[212:215], v99, s[24:27], s44 offen offset:2048 sc0 sc1
    s_add_u32 s44, s44, 96256
    v_mul_f32 v224, v224, v110
    v_mul_f32 v225, v225, v110
    v_mul_f32 v226, v226, v110
    v_mul_f32 v227, v227, v110
    v_mul_f32 v228, v228, v110
    v_mul_f32 v229, v229, v110
    v_mul_f32 v230, v230, v110
    v_mul_f32 v231, v231, v110
    v_mul_f32 v232, v232, v110
    v_mul_f32 v233, v233, v110
    v_mul_f32 v234, v234, v110
    v_mul_f32 v235, v235, v110
    v_mul_f32 v236, v236, v110
    v_mul_f32 v237, v237, v110
    v_mul_f32 v238, v238, v110
    v_mul_f32 v239, v239, v110
    v_cvt_pk_bf16_f32 v224, v224, v225
    v_cvt_pk_bf16_f32 v225, v226, v227
    v_cvt_pk_bf16_f32 v226, v228, v229
    v_cvt_pk_bf16_f32 v227, v230, v231
    v_cvt_pk_bf16_f32 v228, v232, v233
    v_cvt_pk_bf16_f32 v229, v234, v235
    v_cvt_pk_bf16_f32 v230, v236, v237
    v_cvt_pk_bf16_f32 v231, v238, v239
    buffer_store_dwordx4 v[224:227], v99, s[24:27], s44 offen sc0 sc1
    buffer_store_dwordx4 v[228:231], v99, s[24:27], s44 offen offset:2048 sc0 sc1
    s_add_u32 s44, s44, 96256
    v_pk_mul_f32 v[240:241], v[240:241], v[110:111] op_sel:[0,1]
    v_pk_mul_f32 v[242:243], v[242:243], v[110:111] op_sel:[0,1]
    v_pk_mul_f32 v[244:245], v[244:245], v[110:111] op_sel:[0,1]
    v_pk_mul_f32 v[246:247], v[246:247], v[110:111] op_sel:[0,1]
    v_pk_mul_f32 v[248:249], v[248:249], v[110:111] op_sel:[0,1]
    v_pk_mul_f32 v[250:251], v[250:251], v[110:111] op_sel:[0,1]
    v_pk_mul_f32 v[252:253], v[252:253], v[110:111] op_sel:[0,1]
    v_pk_mul_f32 v[254:255], v[254:255], v[110:111] op_sel:[0,1]
    v_cvt_pk_bf16_f32 v240, v240, v241
    v_cvt_pk_bf16_f32 v241, v242, v243
    v_cvt_pk_bf16_f32 v242, v244, v245
    v_cvt_pk_bf16_f32 v243, v246, v247
    v_cvt_pk_bf16_f32 v244, v248, v249
    v_cvt_pk_bf16_f32 v245, v250, v251
    v_cvt_pk_bf16_f32 v246, v252, v253
    v_cvt_pk_bf16_f32 v247, v254, v255
    buffer_store_dwordx4 v[240:243], v99, s[24:27], s44 offen sc0 sc1
    buffer_store_dwordx4 v[244:247], v99, s[24:27], s44 offen offset:2048 sc0 sc1
    s_lshl_b32 s86, s29, 10
    s_lshl_b32 s49, s30, 7
    s_add_u32 s86, s86, s49
    s_add_u32 s86, s86, 5780480
    s_mov_b32 s49, 3
    v_mov_b32 v4, 160000
    v_mov_b32 v5, 1
    v_mov_b32 v6, 0
    s_waitcnt vmcnt(0)
    s_mov_b64 exec, 1
    ds_add_rtn_u32 v7, v4, v5
    s_waitcnt lgkmcnt(0)
    v_readfirstlane_b32 s50, v7
    s_nop 0
    s_cmp_lg_u32 s50, s49
    s_cbranch_scc1 L_f1_q
    buffer_store_dword v5, v6, s[24:27], s86 offen sc1
L_f1_q:
    s_mov_b64 exec, -1
    s_branch L_k1_cend
L_k1_epq:
    s_waitcnt lgkmcnt(10)
    v_mfma_f32_16x16x32_bf16 v[128:131], v[16:19], v[48:51], v[128:131]
    ds_read_b64_tr_b16 v[32:33], v8 offset:49152
    ds_read_b64_tr_b16 v[34:35], v8 offset:49664
    s_waitcnt lgkmcnt(10)
    v_mfma_f32_16x16x32_bf16 v[132:135], v[20:23], v[48:51], v[132:135]
    ds_read_b128 v[76:79], v7 offset:49152
    ds_read_b64_tr_b16 v[36:37], v9 offset:49152
    s_waitcnt lgkmcnt(10)
    v_mfma_f32_16x16x32_bf16 v[136:139], v[24:27], v[48:51], v[136:139]
    ds_read_b64_tr_b16 v[38:39], v9 offset:49664
    ds_read_b64_tr_b16 v[40:41], v8 offset:57344
    s_waitcnt lgkmcnt(10)
    v_mfma_f32_16x16x32_bf16 v[140:143], v[28:31], v[48:51], v[140:143]
    ds_read_b64_tr_b16 v[42:43], v8 offset:57856
    ds_read_b64_tr_b16 v[44:45], v9 offset:57344
    v_mfma_f32_16x16x32_bf16 v[104:107], v[124:127], v[16:19], v[104:107]
    ds_read_b64_tr_b16 v[46:47], v9 offset:57856
    ds_read_b128 v[48:51], v7 offset:51200
    v_mfma_f32_16x16x32_bf16 v[108:111], v[124:127], v[20:23], v[108:111]
    ds_read_b32 v80, v98 offset:0
    ds_read_b32 v82, v98 offset:128
    v_mfma_f32_16x16x32_bf16 v[0:3], v[124:127], v[24:27], v[0:3]
    ds_read_b32 v84, v98 offset:256
    ds_read_b32 v86, v98 offset:384
    v_mfma_f32_16x16x32_bf16 v[100:103], v[124:127], v[28:31], v[100:103]
    ds_read_b32 v88, v98 offset:512
    ds_read_b32 v90, v98 offset:640
    s_waitcnt lgkmcnt(15)
    v_mfma_f32_16x16x32_bf16 v[144:147], v[16:19], v[52:55], v[144:147]
    ds_read_b32 v92, v98 offset:768
    ds_read_b32 v94, v98 offset:896
    v_mfma_f32_16x16x32_bf16 v[148:151], v[20:23], v[52:55], v[148:151]
    v_mfma_f32_16x16x32_bf16 v[152:155], v[24:27], v[52:55], v[152:155]
    v_fmac_f32 v120, 0x3e800000, v104
    v_fmac_f32 v121, 0x3e800000, v108
    v_mfma_f32_16x16x32_bf16 v[156:159], v[28:31], v[52:55], v[156:159]
    v_fmac_f32 v122, 0x3e800000, v0
    v_fmac_f32 v123, 0x3e800000, v100
    v_mfma_f32_16x16x32_bf16 v[160:163], v[16:19], v[56:59], v[160:163]
    ds_write_b128 v96, v[120:123]
    ds_read_b128 v[52:55], v7 offset:53248
    v_mfma_f32_16x16x32_bf16 v[164:167], v[20:23], v[56:59], v[164:167]
    ds_read_b128 v[68:71], v6 offset:59392
    ds_read_b128 v[72:75], v7 offset:55296
    v_mfma_f32_16x16x32_bf16 v[168:171], v[24:27], v[56:59], v[168:171]
    s_waitcnt lgkmcnt(0)
    s_barrier
    v_mfma_f32_16x16x32_bf16 v[172:175], v[28:31], v[56:59], v[172:175]
    ds_read_b128 v[0:3], v97
    ds_read_b128 v[56:59], v6 offset:61440
    v_mfma_f32_16x16x32_bf16 v[128:131], v[32:35], v[76:79], v[128:131]
    v_mfma_f32_16x16x32_bf16 v[132:135], v[36:39], v[76:79], v[132:135]
    v_mfma_f32_16x16x32_bf16 v[136:139], v[40:43], v[76:79], v[136:139]
    v_mfma_f32_16x16x32_bf16 v[140:143], v[44:47], v[76:79], v[140:143]
    s_waitcnt lgkmcnt(1)
    v_add_f32 v0, v0, v120
    v_add_f32 v1, v1, v121
    v_mfma_f32_16x16x32_bf16 v[176:179], v[16:19], v[60:63], v[176:179]
    v_add_f32 v2, v2, v122
    v_add_f32 v3, v3, v123
    v_mfma_f32_16x16x32_bf16 v[180:183], v[20:23], v[60:63], v[180:183]
    v_and_b32 v120, s42, v0
    v_and_b32 v121, s42, v1
    v_mfma_f32_16x16x32_bf16 v[184:187], v[24:27], v[60:63], v[184:187]
    v_and_b32 v122, s42, v2
    v_and_b32 v123, s42, v3
    v_mfma_f32_16x16x32_bf16 v[188:191], v[28:31], v[60:63], v[188:191]
    v_sub_f32 v0, v0, v120
    v_sub_f32 v1, v1, v121
    v_mfma_f32_16x16x32_bf16 v[144:147], v[32:35], v[48:51], v[144:147]
    v_sub_f32 v2, v2, v122
    v_sub_f32 v3, v3, v123
    v_mfma_f32_16x16x32_bf16 v[148:151], v[36:39], v[48:51], v[148:151]
    v_cvt_pk_bf16_f32 v112, v120, v0
    v_cvt_pk_bf16_f32 v114, v121, v1
    v_mfma_f32_16x16x32_bf16 v[152:155], v[40:43], v[48:51], v[152:155]
    v_cvt_pk_bf16_f32 v116, v122, v2
    v_cvt_pk_bf16_f32 v118, v123, v3
    v_mfma_f32_16x16x32_bf16 v[156:159], v[44:47], v[48:51], v[156:159]
    ds_read_b128 v[76:79], v7 offset:57344
    ds_read_b128 v[60:63], v6 offset:63488
    v_mfma_f32_16x16x16_bf16 v[128:131], v[112:113], v[80:81], v[128:131]
    ds_read_b128 v[48:51], v7 offset:59392
    v_mfma_f32_16x16x16_bf16 v[132:135], v[114:115], v[80:81], v[132:135]
    v_mfma_f32_16x16x16_bf16 v[136:139], v[116:117], v[80:81], v[136:139]
    v_mfma_f32_16x16x16_bf16 v[140:143], v[118:119], v[80:81], v[140:143]
    v_mfma_f32_16x16x32_bf16 v[192:195], v[16:19], v[64:67], v[192:195]
    v_mfma_f32_16x16x32_bf16 v[196:199], v[20:23], v[64:67], v[196:199]
    v_mfma_f32_16x16x32_bf16 v[200:203], v[24:27], v[64:67], v[200:203]
    v_max_f32 v128, 0, v128
    v_max_f32 v129, 0, v129
    v_mfma_f32_16x16x32_bf16 v[204:207], v[28:31], v[64:67], v[204:207]
    ds_read_b128 v[64:67], v7 offset:61440
    v_max_f32 v130, 0, v130
    v_mfma_f32_16x16x32_bf16 v[160:163], v[32:35], v[52:55], v[160:163]
    v_max_f32 v131, 0, v131
    v_max_f32 v132, 0, v132
    v_mfma_f32_16x16x32_bf16 v[164:167], v[36:39], v[52:55], v[164:167]
    v_max_f32 v133, 0, v133
    v_max_f32 v134, 0, v134
    v_mfma_f32_16x16x32_bf16 v[168:171], v[40:43], v[52:55], v[168:171]
    v_max_f32 v135, 0, v135
    v_mul_f32 v128, v128, v136
    v_mfma_f32_16x16x32_bf16 v[172:175], v[44:47], v[52:55], v[172:175]
    ds_read_b128 v[52:55], v7 offset:63488
    v_mul_f32 v129, v129, v137
    v_mfma_f32_16x16x16_bf16 v[144:147], v[112:113], v[82:83], v[144:147]
    v_mul_f32 v130, v130, v138
    v_mul_f32 v131, v131, v139
    v_mfma_f32_16x16x16_bf16 v[148:151], v[114:115], v[82:83], v[148:151]
    v_mul_f32 v132, v132, v140
    v_mul_f32 v133, v133, v141
    v_mfma_f32_16x16x16_bf16 v[152:155], v[116:117], v[82:83], v[152:155]
    v_mul_f32 v134, v134, v142
    v_mul_f32 v135, v135, v143
    v_mfma_f32_16x16x16_bf16 v[156:159], v[118:119], v[82:83], v[156:159]
    v_cvt_pk_bf16_f32 v136, v128, v129
    v_cvt_pk_bf16_f32 v137, v130, v131
    v_mfma_f32_16x16x32_bf16 v[208:211], v[16:19], v[68:71], v[208:211]
    v_cvt_pk_bf16_f32 v138, v132, v133
    v_cvt_pk_bf16_f32 v139, v134, v135
    v_mfma_f32_16x16x32_bf16 v[212:215], v[20:23], v[68:71], v[212:215]
    buffer_store_dwordx4 v[136:139], v99, s[24:27], s44 offen sc0 sc1
    s_add_u32 s44, s44, 96256
    v_mfma_f32_16x16x32_bf16 v[216:219], v[24:27], v[68:71], v[216:219]
    v_max_f32 v144, 0, v144
    v_max_f32 v145, 0, v145
    v_mfma_f32_16x16x32_bf16 v[220:223], v[28:31], v[68:71], v[220:223]
    v_max_f32 v146, 0, v146
    v_max_f32 v147, 0, v147
    v_mfma_f32_16x16x32_bf16 v[176:179], v[32:35], v[72:75], v[176:179]
    v_max_f32 v148, 0, v148
    v_max_f32 v149, 0, v149
    v_mfma_f32_16x16x32_bf16 v[180:183], v[36:39], v[72:75], v[180:183]
    v_max_f32 v150, 0, v150
    v_max_f32 v151, 0, v151
    v_mfma_f32_16x16x32_bf16 v[184:187], v[40:43], v[72:75], v[184:187]
    v_mul_f32 v144, v144, v152
    v_mul_f32 v145, v145, v153
    v_mfma_f32_16x16x32_bf16 v[188:191], v[44:47], v[72:75], v[188:191]
    v_mul_f32 v146, v146, v154
    v_mul_f32 v147, v147, v155
    v_mfma_f32_16x16x16_bf16 v[160:163], v[112:113], v[84:85], v[160:163]
    v_mul_f32 v148, v148, v156
    v_mul_f32 v149, v149, v157
    v_mfma_f32_16x16x16_bf16 v[164:167], v[114:115], v[84:85], v[164:167]
    v_mul_f32 v150, v150, v158
    v_mul_f32 v151, v151, v159
    v_mfma_f32_16x16x16_bf16 v[168:171], v[116:117], v[84:85], v[168:171]
    v_cvt_pk_bf16_f32 v152, v144, v145
    v_cvt_pk_bf16_f32 v153, v146, v147
    v_mfma_f32_16x16x16_bf16 v[172:175], v[118:119], v[84:85], v[172:175]
    v_cvt_pk_bf16_f32 v154, v148, v149
    v_cvt_pk_bf16_f32 v155, v150, v151
    s_waitcnt lgkmcnt(5)
    v_mfma_f32_16x16x32_bf16 v[224:227], v[16:19], v[56:59], v[224:227]
    buffer_store_dwordx4 v[152:155], v99, s[24:27], s44 offen sc0 sc1
    s_add_u32 s44, s44, 96256
    v_mfma_f32_16x16x32_bf16 v[228:231], v[20:23], v[56:59], v[228:231]
    v_mfma_f32_16x16x32_bf16 v[232:235], v[24:27], v[56:59], v[232:235]
    v_max_f32 v160, 0, v160
    v_max_f32 v161, 0, v161
    v_mfma_f32_16x16x32_bf16 v[236:239], v[28:31], v[56:59], v[236:239]
    v_max_f32 v162, 0, v162
    v_max_f32 v163, 0, v163
    s_waitcnt lgkmcnt(4)
    v_mfma_f32_16x16x32_bf16 v[192:195], v[32:35], v[76:79], v[192:195]
    v_max_f32 v164, 0, v164
    v_max_f32 v165, 0, v165
    v_mfma_f32_16x16x32_bf16 v[196:199], v[36:39], v[76:79], v[196:199]
    v_max_f32 v166, 0, v166
    v_max_f32 v167, 0, v167
    v_mfma_f32_16x16x32_bf16 v[200:203], v[40:43], v[76:79], v[200:203]
    v_mul_f32 v160, v160, v168
    v_mul_f32 v161, v161, v169
    v_mfma_f32_16x16x32_bf16 v[204:207], v[44:47], v[76:79], v[204:207]
    v_mul_f32 v162, v162, v170
    v_mul_f32 v163, v163, v171
    v_mfma_f32_16x16x16_bf16 v[176:179], v[112:113], v[86:87], v[176:179]
    v_mul_f32 v164, v164, v172
    v_mul_f32 v165, v165, v173
    v_mfma_f32_16x16x16_bf16 v[180:183], v[114:115], v[86:87], v[180:183]
    v_mul_f32 v166, v166, v174
    v_mul_f32 v167, v167, v175
    v_mfma_f32_16x16x16_bf16 v[184:187], v[116:117], v[86:87], v[184:187]
    v_cvt_pk_bf16_f32 v168, v160, v161
    v_cvt_pk_bf16_f32 v169, v162, v163
    v_mfma_f32_16x16x16_bf16 v[188:191], v[118:119], v[86:87], v[188:191]
    v_cvt_pk_bf16_f32 v170, v164, v165
    v_cvt_pk_bf16_f32 v171, v166, v167
    s_waitcnt lgkmcnt(3)
    v_mfma_f32_16x16x32_bf16 v[240:243], v[16:19], v[60:63], v[240:243]
    buffer_store_dwordx4 v[168:171], v99, s[24:27], s44 offen sc0 sc1
    s_add_u32 s44, s44, 96256
    v_mfma_f32_16x16x32_bf16 v[244:247], v[20:23], v[60:63], v[244:247]
    v_mfma_f32_16x16x32_bf16 v[248:251], v[24:27], v[60:63], v[248:251]
    v_max_f32 v176, 0, v176
    v_max_f32 v177, 0, v177
    v_mfma_f32_16x16x32_bf16 v[252:255], v[28:31], v[60:63], v[252:255]
    v_max_f32 v178, 0, v178
    v_max_f32 v179, 0, v179
    s_waitcnt lgkmcnt(2)
    v_mfma_f32_16x16x32_bf16 v[208:211], v[32:35], v[48:51], v[208:211]
    v_max_f32 v180, 0, v180
    v_max_f32 v181, 0, v181
    v_mfma_f32_16x16x32_bf16 v[212:215], v[36:39], v[48:51], v[212:215]
    v_max_f32 v182, 0, v182
    v_max_f32 v183, 0, v183
    v_mfma_f32_16x16x32_bf16 v[216:219], v[40:43], v[48:51], v[216:219]
    v_mul_f32 v176, v176, v184
    v_mul_f32 v177, v177, v185
    v_mfma_f32_16x16x32_bf16 v[220:223], v[44:47], v[48:51], v[220:223]
    v_mul_f32 v178, v178, v186
    v_mul_f32 v179, v179, v187
    v_mfma_f32_16x16x16_bf16 v[192:195], v[112:113], v[88:89], v[192:195]
    v_mul_f32 v180, v180, v188
    v_mul_f32 v181, v181, v189
    v_mfma_f32_16x16x16_bf16 v[196:199], v[114:115], v[88:89], v[196:199]
    v_mul_f32 v182, v182, v190
    v_mul_f32 v183, v183, v191
    v_mfma_f32_16x16x16_bf16 v[200:203], v[116:117], v[88:89], v[200:203]
    v_cvt_pk_bf16_f32 v184, v176, v177
    v_cvt_pk_bf16_f32 v185, v178, v179
    v_mfma_f32_16x16x16_bf16 v[204:207], v[118:119], v[88:89], v[204:207]
    v_cvt_pk_bf16_f32 v186, v180, v181
    v_cvt_pk_bf16_f32 v187, v182, v183
    s_waitcnt lgkmcnt(1)
    v_mfma_f32_16x16x32_bf16 v[224:227], v[32:35], v[64:67], v[224:227]
    buffer_store_dwordx4 v[184:187], v99, s[24:27], s44 offen sc0 sc1
    s_add_u32 s44, s44, 96256
    v_mfma_f32_16x16x32_bf16 v[228:231], v[36:39], v[64:67], v[228:231]
    v_mfma_f32_16x16x32_bf16 v[232:235], v[40:43], v[64:67], v[232:235]
    v_max_f32 v192, 0, v192
    v_max_f32 v193, 0, v193
    v_mfma_f32_16x16x32_bf16 v[236:239], v[44:47], v[64:67], v[236:239]
    v_max_f32 v194, 0, v194
    v_max_f32 v195, 0, v195
    v_mfma_f32_16x16x16_bf16 v[208:211], v[112:113], v[90:91], v[208:211]
    v_max_f32 v196, 0, v196
    v_max_f32 v197, 0, v197
    v_mfma_f32_16x16x16_bf16 v[212:215], v[114:115], v[90:91], v[212:215]
    v_max_f32 v198, 0, v198
    v_max_f32 v199, 0, v199
    v_mfma_f32_16x16x16_bf16 v[216:219], v[116:117], v[90:91], v[216:219]
    v_mul_f32 v192, v192, v200
    v_mul_f32 v193, v193, v201
    v_mfma_f32_16x16x16_bf16 v[220:223], v[118:119], v[90:91], v[220:223]
    v_mul_f32 v194, v194, v202
    v_mul_f32 v195, v195, v203
    s_waitcnt lgkmcnt(0)
    v_mfma_f32_16x16x32_bf16 v[240:243], v[32:35], v[52:55], v[240:243]
    v_mul_f32 v196, v196, v204
    v_mul_f32 v197, v197, v205
    v_mfma_f32_16x16x32_bf16 v[244:247], v[36:39], v[52:55], v[244:247]
    v_mul_f32 v198, v198, v206
    v_mul_f32 v199, v199, v207
    v_mfma_f32_16x16x32_bf16 v[248:251], v[40:43], v[52:55], v[248:251]
    v_cvt_pk_bf16_f32 v200, v192, v193
    v_cvt_pk_bf16_f32 v201, v194, v195
    v_mfma_f32_16x16x32_bf16 v[252:255], v[44:47], v[52:55], v[252:255]
    v_cvt_pk_bf16_f32 v202, v196, v197
    v_cvt_pk_bf16_f32 v203, v198, v199
    v_mfma_f32_16x16x16_bf16 v[224:227], v[112:113], v[92:93], v[224:227]
    buffer_store_dwordx4 v[200:203], v99, s[24:27], s44 offen sc0 sc1
    s_add_u32 s44, s44, 96256
    v_mfma_f32_16x16x16_bf16 v[228:231], v[114:115], v[92:93], v[228:231]
    v_max_f32 v208, 0, v208
    v_max_f32 v209, 0, v209
    v_mfma_f32_16x16x16_bf16 v[232:235], v[116:117], v[92:93], v[232:235]
    v_max_f32 v210, 0, v210
    v_max_f32 v211, 0, v211
    v_mfma_f32_16x16x16_bf16 v[236:239], v[118:119], v[92:93], v[236:239]
    v_max_f32 v212, 0, v212
    v_max_f32 v213, 0, v213
    v_mfma_f32_16x16x16_bf16 v[240:243], v[112:113], v[94:95], v[240:243]
    v_max_f32 v214, 0, v214
    v_max_f32 v215, 0, v215
    v_mfma_f32_16x16x16_bf16 v[244:247], v[114:115], v[94:95], v[244:247]
    v_mul_f32 v208, v208, v216
    v_mul_f32 v209, v209, v217
    v_mfma_f32_16x16x16_bf16 v[248:251], v[116:117], v[94:95], v[248:251]
    v_mul_f32 v210, v210, v218
    v_mul_f32 v211, v211, v219
    v_mfma_f32_16x16x16_bf16 v[252:255], v[118:119], v[94:95], v[252:255]
    v_mul_f32 v212, v212, v220
    v_mul_f32 v213, v213, v221
    v_mul_f32 v214, v214, v222
    v_mul_f32 v215, v215, v223
    v_cvt_pk_bf16_f32 v216, v208, v209
    v_cvt_pk_bf16_f32 v217, v210, v211
    v_cvt_pk_bf16_f32 v218, v212, v213
    v_cvt_pk_bf16_f32 v219, v214, v215
    buffer_store_dwordx4 v[216:219], v99, s[24:27], s44 offen sc0 sc1
    s_add_u32 s44, s44, 96256
    v_max_f32 v224, 0, v224
    v_max_f32 v225, 0, v225
    v_max_f32 v226, 0, v226
    v_max_f32 v227, 0, v227
    v_max_f32 v228, 0, v228
    v_max_f32 v229, 0, v229
    v_max_f32 v230, 0, v230
    v_max_f32 v231, 0, v231
    v_mul_f32 v224, v224, v232
    v_mul_f32 v225, v225, v233
    v_mul_f32 v226, v226, v234
    v_mul_f32 v227, v227, v235
    v_mul_f32 v228, v228, v236
    v_mul_f32 v229, v229, v237
    v_mul_f32 v230, v230, v238
    v_mul_f32 v231, v231, v239
    v_cvt_pk_bf16_f32 v232, v224, v225
    v_cvt_pk_bf16_f32 v233, v226, v227
    v_cvt_pk_bf16_f32 v234, v228, v229
    v_cvt_pk_bf16_f32 v235, v230, v231
    buffer_store_dwordx4 v[232:235], v99, s[24:27], s44 offen sc0 sc1
    s_add_u32 s44, s44, 96256
    v_max_f32 v240, 0, v240
    v_max_f32 v241, 0, v241
    v_max_f32 v242, 0, v242
    v_max_f32 v243, 0, v243
    v_max_f32 v244, 0, v244
    v_max_f32 v245, 0, v245
    v_max_f32 v246, 0, v246
    v_max_f32 v247, 0, v247
    v_pk_mul_f32 v[240:241], v[240:241], v[248:249]
    v_pk_mul_f32 v[242:243], v[242:243], v[250:251]
    v_pk_mul_f32 v[244:245], v[244:245], v[252:253]
    v_pk_mul_f32 v[246:247], v[246:247], v[254:255]
    v_cvt_pk_bf16_f32 v248, v240, v241
    v_cvt_pk_bf16_f32 v249, v242, v243
    v_cvt_pk_bf16_f32 v250, v244, v245
    v_cvt_pk_bf16_f32 v251, v246, v247
    buffer_store_dwordx4 v[248:251], v99, s[24:27], s44 offen sc0 sc1
L_k1_cend:
    v_mbcnt_lo_u32_b32 v1, -1, 0
    v_mbcnt_hi_u32_b32 v1, -1, v1
    s_bfe_u32 s29, s2, 0x20001
    s_lshl_b32 s29, s29, 3
    s_lshr_b32 s30, s2, 5
    s_add_u32 s29, s29, s30
    s_and_b32 s30, s2, 1
    s_lshl_b32 s30, s30, 2
    s_bfe_u32 s31, s2, 0x20003
    s_add_u32 s30, s30, s31
    v_lshlrev_b32 v8, 4, v1
    v_lshlrev_b32 v10, 3, v1
    s_mul_i32 s41, s28, 57344
    s_add_u32 s41, s41, 5242880
    s_add_u32 s42, s41, 57344
    s_mul_i32 s33, s30, 7168
    s_add_u32 s40, s41, s33
    v_add_u32 v9, 3584, v8
    v_add_u32 v11, 3584, v10
    v_lshrrev_b32 v5, 5, v1
    v_bfe_u32 v7, v1, 4, 1
    v_mul_u32_u24 v6, 96256, v7
    v_and_b32 v3, 15, v1
    v_lshl_add_u32 v6, v3, 4, v6
    v_lshl_add_u32 v6, v5, 8, v6
    v_lshlrev_b32 v4, 12, v7
    v_lshl_add_u32 v4, v3, 4, v4
    s_and_b32 s34, s30, 1
    s_lshl_b32 s34, s34, 2
    s_lshl_b32 s32, s28, 1
    v_mov_b64 v[252:253], 0
    v_mov_b32 v2, 160000
L_att_kv:
    ds_read_b32 v3, v2 offset:4
    s_waitcnt lgkmcnt(0)
    v_readfirstlane_b32 s50, v3
    s_nop 0
    s_cmp_eq_u32 s50, 0
    s_cbranch_scc1 L_att_kv
    buffer_load_dwordx2 v[232:233], v10, s[24:27], s40 offen offset:3072 sc1
    buffer_load_dwordx4 v[220:223], v8, s[24:27], s40 offen offset:0 sc1
    buffer_load_dwordx4 v[224:227], v8, s[24:27], s40 offen offset:1024 sc1
    buffer_load_dwordx4 v[228:231], v8, s[24:27], s40 offen offset:2048 sc1
    buffer_load_dwordx4 v[234:237], v9, s[24:27], s40 offen offset:0 sc1
    buffer_load_dwordx2 v[246:247], v11, s[24:27], s40 offen offset:3072 sc1
    s_add_u32 s33, s32, 2
    s_and_b32 s43, s33, 4
    s_lshl_b32 s43, s43, 11
    s_add_u32 s43, s43, 16384
    s_and_b32 s33, s33, 3
    s_mul_i32 s33, s33, 5
    s_add_u32 s33, s33, s34
    v_add_u32 v7, s33, v5
    v_add_u32 v2, s43, v4
    v_mfma_f32_32x32x8_bf16 v[60:75], v[252:253], v[252:253], 0
    v_lshrrev_b32 v3, 3, v7
    v_lshl_add_u32 v188, v3, 10, v2
    v_and_b32 v3, 3, v7
    v_lshl_add_u32 v188, v3, 8, v188
    v_and_b32 v3, 4, v7
    v_lshl_add_u32 v188, v3, 1, v188
    v_xor_b32 v200, 0x2000, v188
    v_add_u32 v7, 2, v7
    v_mfma_f32_32x32x8_bf16 v[76:91], v[252:253], v[252:253], 0
    v_lshrrev_b32 v3, 3, v7
    v_lshl_add_u32 v189, v3, 10, v2
    v_and_b32 v3, 3, v7
    v_lshl_add_u32 v189, v3, 8, v189
    v_and_b32 v3, 4, v7
    v_lshl_add_u32 v189, v3, 1, v189
    v_xor_b32 v201, 0x2000, v189
    v_add_u32 v7, 2, v7
    v_lshrrev_b32 v3, 3, v7
    v_lshl_add_u32 v190, v3, 10, v2
    v_and_b32 v3, 3, v7
    v_lshl_add_u32 v190, v3, 8, v190
    v_and_b32 v3, 4, v7
    v_lshl_add_u32 v190, v3, 1, v190
    v_xor_b32 v202, 0x2000, v190
    s_add_u32 s33, s32, 3
    s_and_b32 s43, s33, 4
    s_lshl_b32 s43, s43, 11
    s_add_u32 s43, s43, 16384
    s_and_b32 s33, s33, 3
    s_mul_i32 s33, s33, 5
    s_add_u32 s33, s33, s34
    v_add_u32 v7, s33, v5
    v_add_u32 v2, s43, v4
    v_mfma_f32_32x32x8_bf16 v[92:107], v[252:253], v[252:253], 0
    v_lshrrev_b32 v3, 3, v7
    v_lshl_add_u32 v191, v3, 10, v2
    v_and_b32 v3, 3, v7
    v_lshl_add_u32 v191, v3, 8, v191
    v_and_b32 v3, 4, v7
    v_lshl_add_u32 v191, v3, 1, v191
    v_xor_b32 v203, 0x2000, v191
    v_add_u32 v7, 2, v7
    v_mfma_f32_32x32x8_bf16 v[108:123], v[252:253], v[252:253], 0
    v_lshrrev_b32 v3, 3, v7
    v_lshl_add_u32 v192, v3, 10, v2
    v_and_b32 v3, 3, v7
    v_lshl_add_u32 v192, v3, 8, v192
    v_and_b32 v3, 4, v7
    v_lshl_add_u32 v192, v3, 1, v192
    v_xor_b32 v204, 0x2000, v192
    v_add_u32 v7, 2, v7
    v_lshrrev_b32 v3, 3, v7
    v_lshl_add_u32 v193, v3, 10, v2
    v_and_b32 v3, 3, v7
    v_lshl_add_u32 v193, v3, 8, v193
    v_and_b32 v3, 4, v7
    v_lshl_add_u32 v193, v3, 1, v193
    v_xor_b32 v205, 0x2000, v193
    s_add_u32 s33, s32, 4
    s_and_b32 s43, s33, 4
    s_lshl_b32 s43, s43, 11
    s_add_u32 s43, s43, 16384
    s_and_b32 s33, s33, 3
    s_mul_i32 s33, s33, 5
    s_add_u32 s33, s33, s34
    v_add_u32 v7, s33, v5
    v_add_u32 v2, s43, v4
    v_mfma_f32_32x32x8_bf16 v[124:139], v[252:253], v[252:253], 0
    v_lshrrev_b32 v3, 3, v7
    v_lshl_add_u32 v194, v3, 10, v2
    v_and_b32 v3, 3, v7
    v_lshl_add_u32 v194, v3, 8, v194
    v_and_b32 v3, 4, v7
    v_lshl_add_u32 v194, v3, 1, v194
    v_xor_b32 v206, 0x2000, v194
    v_add_u32 v7, 2, v7
    v_mfma_f32_32x32x8_bf16 v[140:155], v[252:253], v[252:253], 0
    v_lshrrev_b32 v3, 3, v7
    v_lshl_add_u32 v195, v3, 10, v2
    v_and_b32 v3, 3, v7
    v_lshl_add_u32 v195, v3, 8, v195
    v_and_b32 v3, 4, v7
    v_lshl_add_u32 v195, v3, 1, v195
    v_xor_b32 v207, 0x2000, v195
    v_add_u32 v7, 2, v7
    v_lshrrev_b32 v3, 3, v7
    v_lshl_add_u32 v196, v3, 10, v2
    v_and_b32 v3, 3, v7
    v_lshl_add_u32 v196, v3, 8, v196
    v_and_b32 v3, 4, v7
    v_lshl_add_u32 v196, v3, 1, v196
    v_xor_b32 v208, 0x2000, v196
    s_add_u32 s33, s32, 5
    s_and_b32 s43, s33, 4
    s_lshl_b32 s43, s43, 11
    s_add_u32 s43, s43, 16384
    s_and_b32 s33, s33, 3
    s_mul_i32 s33, s33, 5
    s_add_u32 s33, s33, s34
    v_add_u32 v7, s33, v5
    v_add_u32 v2, s43, v4
    v_mfma_f32_32x32x8_bf16 v[156:171], v[252:253], v[252:253], 0
    v_lshrrev_b32 v3, 3, v7
    v_lshl_add_u32 v197, v3, 10, v2
    v_and_b32 v3, 3, v7
    v_lshl_add_u32 v197, v3, 8, v197
    v_and_b32 v3, 4, v7
    v_lshl_add_u32 v197, v3, 1, v197
    v_xor_b32 v209, 0x2000, v197
    v_add_u32 v7, 2, v7
    v_mfma_f32_32x32x8_bf16 v[172:187], v[252:253], v[252:253], 0
    v_lshrrev_b32 v3, 3, v7
    v_lshl_add_u32 v198, v3, 10, v2
    v_and_b32 v3, 3, v7
    v_lshl_add_u32 v198, v3, 8, v198
    v_and_b32 v3, 4, v7
    v_lshl_add_u32 v198, v3, 1, v198
    v_xor_b32 v210, 0x2000, v198
    v_add_u32 v7, 2, v7
    v_lshrrev_b32 v3, 3, v7
    v_lshl_add_u32 v199, v3, 10, v2
    v_and_b32 v3, 3, v7
    v_lshl_add_u32 v199, v3, 8, v199
    v_and_b32 v3, 4, v7
    v_lshl_add_u32 v199, v3, 1, v199
    v_xor_b32 v211, 0x2000, v199
    v_mov_b64 v[16:17], 0
    v_mov_b64 v[22:23], 0
    v_mov_b64 v[28:29], 0
    v_mov_b64 v[34:35], 0
    v_mov_b64 v[40:41], 0
    v_mov_b64 v[46:47], 0
    v_mov_b64 v[52:53], 0
    v_mov_b64 v[58:59], 0
    s_lshr_b32 s34, s28, 1
    s_lshl_b32 s36, s29, 1
    s_add_u32 s36, s36, s34
    s_lshl_b32 s39, s36, 7
    s_add_u32 s39, s39, 5767168
    s_mul_i32 s37, s36, 192512
    s_mul_i32 s34, s30, 2560
    s_add_u32 s37, s37, s34
    s_and_b32 s38, s28, 1
    s_mul_i32 s34, s38, 1280
    s_add_u32 s37, s37, s34
    s_add_u32 s37, s37, 6346752
    s_lshl_b32 s34, s30, 1
    s_add_u32 s38, s38, s34
    s_lshl_b32 s38, s38, 2
    s_add_u32 s39, s39, s38
    v_mov_b32 v2, 160000
    v_mov_b32 v3, 1
    s_waitcnt vmcnt(6)
    s_mov_b64 exec, 1
    ds_add_u32 v2, v3 offset:12
    s_mov_b64 exec, -1
    s_mul_i32 s33, s28, 19968
    s_add_u32 s33, s33, 64
    v_add_u32 v248, s33, v8
    v_lshl_add_u32 v249, v1, 2, s33
    s_sub_u32 s33, s28, 1
    s_and_b32 s33, s33, 3
    s_mul_i32 s33, s33, 19968
    s_add_u32 s56, s33, 64
    s_sub_u32 s33, s28, 2
    s_and_b32 s33, s33, 3
    s_mul_i32 s33, s33, 19968
    s_add_u32 s57, s33, 6720
    s_sub_u32 s33, s28, 3
    s_and_b32 s33, s33, 3
    s_mul_i32 s33, s33, 19968
    s_add_u32 s58, s33, 13376
    s_mov_b32 s47, 0x21800000
    s_mov_b32 s48, 0x5d800000
    v_mov_b32 v4, 0
    v_mov_b32 v2, 0xdddddddd
    v_mov_b64 v[212:213], 0
    v_mov_b64 v[214:215], 0
    v_mov_b64 v[216:217], 0
    v_mov_b64 v[218:219], 0
    v_mov_b64 v[242:243], 0
    v_mov_b64 v[244:245], 0
    s_mov_b32 s46, 0
    s_setprio 1
    s_waitcnt vmcnt(4)
    s_barrier
    ds_read_b64 v[12:13], v188
    ds_read_b64 v[14:15], v189
    s_mov_b32 exec_hi, 0
    ds_read_b64 v[16:17], v190
    ds_read_b64 v[22:23], v193
    ds_read_b64 v[28:29], v196
    ds_read_b64 v[34:35], v199
    ds_read_b64 v[40:41], v202
    ds_read_b64 v[46:47], v205
    ds_read_b64 v[52:53], v208
    ds_read_b64 v[58:59], v211
    s_mov_b32 exec_hi, -1
    ds_read_b64 v[18:19], v191
    ds_read_b64 v[20:21], v192
    ds_read_b64 v[24:25], v194
    ds_read_b64 v[26:27], v195
    ds_read_b64 v[30:31], v197
    ds_read_b64 v[32:33], v198
    ds_read_b64 v[36:37], v200
    ds_read_b64 v[38:39], v201
    ds_read_b64 v[42:43], v203
    ds_read_b64 v[44:45], v204
    ds_read_b64 v[48:49], v206
    ds_read_b64 v[50:51], v207
    ds_read_b64 v[54:55], v209
    ds_read_b64 v[56:57], v210
    s_waitcnt lgkmcnt(14)
L_att_start:
    v_mfma_f32_32x32x8_bf16 v[188:203], v[232:233], v[16:17], 0
    v_mfma_f32_32x32x16_bf16 v[188:203], v[220:223], v[12:15], v[188:203]
    s_mov_b32 s43, 7
    s_waitcnt lgkmcnt(0)
    s_nop 9
    .p2align 6
L_att_loop:
    v_exp_f32 v188, v188
    v_exp_f32 v189, v189
    v_smfmac_f32_32x32x32_bf16 v[172:187], v[242:245], v[212:219], v2
    v_exp_f32 v190, v190
    v_exp_f32 v191, v191
    buffer_load_dwordx4 v[238:241], v9, s[24:27], s40 offen offset:1024 sc1
    v_exp_f32 v192, v192
    v_exp_f32 v193, v193
    v_mfma_f32_32x32x8_bf16 v[204:219], v[232:233], v[22:23], 0
    v_exp_f32 v194, v194
    v_exp_f32 v195, v195
    buffer_load_dwordx4 v[242:245], v9, s[24:27], s40 offen offset:2048 sc1
    s_add_u32 s40, s40, 7168
    s_cmp_eq_u32 s40, s42
    s_cselect_b32 s40, s41, s40
    v_exp_f32 v196, v196
    v_exp_f32 v197, v197
    v_mfma_f32_32x32x16_bf16 v[204:219], v[220:223], v[18:21], v[204:219]
    v_exp_f32 v198, v198
    v_exp_f32 v199, v199
    v_exp_f32 v200, v200
    v_exp_f32 v201, v201
    s_waitcnt vmcnt(5)
    v_smfmac_f32_32x32x32_bf16 v[60:75], v[224:227], v[188:195], v2
    v_exp_f32 v202, v202
    v_exp_f32 v203, v203
    v_exp_f32 v204, v204
    v_exp_f32 v205, v205
    s_waitcnt vmcnt(4)
    v_smfmac_f32_32x32x32_bf16 v[60:75], v[228:231], v[196:203], v2
    v_exp_f32 v206, v206
    v_exp_f32 v207, v207
    v_exp_f32 v208, v208
    v_exp_f32 v209, v209
    v_mfma_f32_32x32x8_bf16 v[188:203], v[232:233], v[28:29], 0
    v_exp_f32 v210, v210
    v_exp_f32 v211, v211
    v_exp_f32 v212, v212
    v_exp_f32 v213, v213
    v_mfma_f32_32x32x16_bf16 v[188:203], v[220:223], v[24:27], v[188:203]
    v_exp_f32 v214, v214
    v_exp_f32 v215, v215
    v_exp_f32 v216, v216
    v_exp_f32 v217, v217
    v_smfmac_f32_32x32x32_bf16 v[76:91], v[224:227], v[204:211], v2
    v_exp_f32 v218, v218
    v_exp_f32 v219, v219
    v_exp_f32 v188, v188
    v_exp_f32 v189, v189
    v_smfmac_f32_32x32x32_bf16 v[76:91], v[228:231], v[212:219], v2
    v_exp_f32 v190, v190
    v_exp_f32 v191, v191
    v_exp_f32 v192, v192
    v_exp_f32 v193, v193
    v_mfma_f32_32x32x8_bf16 v[204:219], v[232:233], v[34:35], 0
    v_exp_f32 v194, v194
    v_exp_f32 v195, v195
    v_exp_f32 v196, v196
    v_exp_f32 v197, v197
    v_mfma_f32_32x32x16_bf16 v[204:219], v[220:223], v[30:33], v[204:219]
    v_exp_f32 v198, v198
    v_exp_f32 v199, v199
    v_exp_f32 v200, v200
    v_exp_f32 v201, v201
    v_smfmac_f32_32x32x32_bf16 v[92:107], v[224:227], v[188:195], v2
    v_exp_f32 v202, v202
    v_exp_f32 v203, v203
    v_exp_f32 v204, v204
    v_exp_f32 v205, v205
    v_smfmac_f32_32x32x32_bf16 v[92:107], v[228:231], v[196:203], v2
    v_exp_f32 v206, v206
    v_exp_f32 v207, v207
    v_exp_f32 v208, v208
    v_exp_f32 v209, v209
    v_mfma_f32_32x32x8_bf16 v[188:203], v[232:233], v[40:41], 0
    v_exp_f32 v210, v210
    v_exp_f32 v211, v211
    v_exp_f32 v212, v212
    v_exp_f32 v213, v213
    v_mfma_f32_32x32x16_bf16 v[188:203], v[220:223], v[36:39], v[188:203]
    v_exp_f32 v214, v214
    v_exp_f32 v215, v215
    v_exp_f32 v216, v216
    v_exp_f32 v217, v217
    v_smfmac_f32_32x32x32_bf16 v[108:123], v[224:227], v[204:211], v2
    v_exp_f32 v218, v218
    v_exp_f32 v219, v219
    v_exp_f32 v188, v188
    v_exp_f32 v189, v189
    v_smfmac_f32_32x32x32_bf16 v[108:123], v[228:231], v[212:219], v2
    v_exp_f32 v190, v190
    v_exp_f32 v191, v191
    v_exp_f32 v192, v192
    v_exp_f32 v193, v193
    v_mfma_f32_32x32x8_bf16 v[204:219], v[232:233], v[46:47], 0
    v_exp_f32 v194, v194
    v_exp_f32 v195, v195
    v_exp_f32 v196, v196
    v_exp_f32 v197, v197
    v_mfma_f32_32x32x16_bf16 v[204:219], v[220:223], v[42:45], v[204:219]
    v_exp_f32 v198, v198
    v_exp_f32 v199, v199
    v_exp_f32 v200, v200
    v_exp_f32 v201, v201
    v_smfmac_f32_32x32x32_bf16 v[124:139], v[224:227], v[188:195], v2
    v_exp_f32 v202, v202
    v_exp_f32 v203, v203
    v_exp_f32 v204, v204
    v_exp_f32 v205, v205
    v_smfmac_f32_32x32x32_bf16 v[124:139], v[228:231], v[196:203], v2
    v_exp_f32 v206, v206
    v_exp_f32 v207, v207
    v_exp_f32 v208, v208
    v_exp_f32 v209, v209
    v_mfma_f32_32x32x8_bf16 v[188:203], v[232:233], v[52:53], 0
    v_exp_f32 v210, v210
    v_exp_f32 v211, v211
    v_exp_f32 v212, v212
    v_exp_f32 v213, v213
    v_mfma_f32_32x32x16_bf16 v[188:203], v[220:223], v[48:51], v[188:203]
    v_exp_f32 v214, v214
    v_exp_f32 v215, v215
    v_exp_f32 v216, v216
    v_exp_f32 v217, v217
    v_smfmac_f32_32x32x32_bf16 v[140:155], v[224:227], v[204:211], v2
    v_exp_f32 v218, v218
    v_exp_f32 v219, v219
    v_exp_f32 v188, v188
    v_exp_f32 v189, v189
    v_smfmac_f32_32x32x32_bf16 v[140:155], v[228:231], v[212:219], v2
    v_exp_f32 v190, v190
    v_exp_f32 v191, v191
    v_exp_f32 v192, v192
    v_exp_f32 v193, v193
    v_mfma_f32_32x32x8_bf16 v[204:219], v[232:233], v[58:59], 0
    v_exp_f32 v194, v194
    v_exp_f32 v195, v195
    v_exp_f32 v196, v196
    v_exp_f32 v197, v197
    v_mfma_f32_32x32x16_bf16 v[204:219], v[220:223], v[54:57], v[204:219]
    v_exp_f32 v198, v198
    v_exp_f32 v199, v199
    v_exp_f32 v200, v200
    v_exp_f32 v201, v201
    v_smfmac_f32_32x32x32_bf16 v[156:171], v[224:227], v[188:195], v2
    v_exp_f32 v202, v202
    v_exp_f32 v203, v203
    v_exp_f32 v204, v204
    v_exp_f32 v205, v205
    v_smfmac_f32_32x32x32_bf16 v[156:171], v[228:231], v[196:203], v2
    v_exp_f32 v206, v206
    v_exp_f32 v207, v207
    buffer_load_dwordx4 v[220:223], v8, s[24:27], s40 offen offset:0 sc1
    v_exp_f32 v208, v208
    v_exp_f32 v209, v209
    s_waitcnt vmcnt(3)
    v_mfma_f32_32x32x8_bf16 v[188:203], v[246:247], v[16:17], 0
    v_exp_f32 v210, v210
    v_exp_f32 v211, v211
    buffer_load_dwordx2 v[232:233], v10, s[24:27], s40 offen offset:3072 sc1
    v_exp_f32 v212, v212
    v_exp_f32 v213, v213
    v_mfma_f32_32x32x16_bf16 v[188:203], v[234:237], v[12:15], v[188:203]
    v_exp_f32 v214, v214
    v_exp_f32 v215, v215
    v_exp_f32 v216, v216
    v_exp_f32 v217, v217
    v_smfmac_f32_32x32x32_bf16 v[172:187], v[224:227], v[204:211], v2
    v_exp_f32 v218, v218
    v_exp_f32 v219, v219
    v_exp_f32 v188, v188
    v_exp_f32 v189, v189
    v_smfmac_f32_32x32x32_bf16 v[172:187], v[228:231], v[212:219], v2
    v_exp_f32 v190, v190
    v_exp_f32 v191, v191
    buffer_load_dwordx4 v[224:227], v8, s[24:27], s40 offen offset:1024 sc1
    v_exp_f32 v192, v192
    v_exp_f32 v193, v193
    v_mfma_f32_32x32x8_bf16 v[204:219], v[246:247], v[22:23], 0
    v_exp_f32 v194, v194
    v_exp_f32 v195, v195
    buffer_load_dwordx4 v[228:231], v8, s[24:27], s40 offen offset:2048 sc1
    v_exp_f32 v196, v196
    v_exp_f32 v197, v197
    v_mfma_f32_32x32x16_bf16 v[204:219], v[234:237], v[18:21], v[204:219]
    v_exp_f32 v198, v198
    v_exp_f32 v199, v199
    v_exp_f32 v200, v200
    v_exp_f32 v201, v201
    s_waitcnt vmcnt(5)
    v_smfmac_f32_32x32x32_bf16 v[60:75], v[238:241], v[188:195], v2
    v_exp_f32 v202, v202
    v_exp_f32 v203, v203
    v_exp_f32 v204, v204
    v_exp_f32 v205, v205
    s_waitcnt vmcnt(4)
    v_smfmac_f32_32x32x32_bf16 v[60:75], v[242:245], v[196:203], v2
    v_exp_f32 v206, v206
    v_exp_f32 v207, v207
    v_exp_f32 v208, v208
    v_exp_f32 v209, v209
    v_mfma_f32_32x32x8_bf16 v[188:203], v[246:247], v[28:29], 0
    v_exp_f32 v210, v210
    v_exp_f32 v211, v211
    v_exp_f32 v212, v212
    v_exp_f32 v213, v213
    v_mfma_f32_32x32x16_bf16 v[188:203], v[234:237], v[24:27], v[188:203]
    v_exp_f32 v214, v214
    v_exp_f32 v215, v215
    v_exp_f32 v216, v216
    v_exp_f32 v217, v217
    v_smfmac_f32_32x32x32_bf16 v[76:91], v[238:241], v[204:211], v2
    v_exp_f32 v218, v218
    v_exp_f32 v219, v219
    v_exp_f32 v188, v188
    v_exp_f32 v189, v189
    v_smfmac_f32_32x32x32_bf16 v[76:91], v[242:245], v[212:219], v2
    v_exp_f32 v190, v190
    v_exp_f32 v191, v191
    v_exp_f32 v192, v192
    v_exp_f32 v193, v193
    v_mfma_f32_32x32x8_bf16 v[204:219], v[246:247], v[34:35], 0
    v_exp_f32 v194, v194
    v_exp_f32 v195, v195
    v_exp_f32 v196, v196
    v_exp_f32 v197, v197
    v_mfma_f32_32x32x16_bf16 v[204:219], v[234:237], v[30:33], v[204:219]
    v_exp_f32 v198, v198
    v_exp_f32 v199, v199
    v_exp_f32 v200, v200
    v_exp_f32 v201, v201
    v_smfmac_f32_32x32x32_bf16 v[92:107], v[238:241], v[188:195], v2
    v_exp_f32 v202, v202
    v_exp_f32 v203, v203
    v_exp_f32 v204, v204
    v_exp_f32 v205, v205
    v_smfmac_f32_32x32x32_bf16 v[92:107], v[242:245], v[196:203], v2
    v_exp_f32 v206, v206
    v_exp_f32 v207, v207
    v_exp_f32 v208, v208
    v_exp_f32 v209, v209
    v_mfma_f32_32x32x8_bf16 v[188:203], v[246:247], v[40:41], 0
    v_exp_f32 v210, v210
    v_exp_f32 v211, v211
    v_exp_f32 v212, v212
    v_exp_f32 v213, v213
    v_mfma_f32_32x32x16_bf16 v[188:203], v[234:237], v[36:39], v[188:203]
    v_exp_f32 v214, v214
    v_exp_f32 v215, v215
    v_exp_f32 v216, v216
    v_exp_f32 v217, v217
    v_smfmac_f32_32x32x32_bf16 v[108:123], v[238:241], v[204:211], v2
    v_exp_f32 v218, v218
    v_exp_f32 v219, v219
    v_exp_f32 v188, v188
    v_exp_f32 v189, v189
    v_smfmac_f32_32x32x32_bf16 v[108:123], v[242:245], v[212:219], v2
    v_exp_f32 v190, v190
    v_exp_f32 v191, v191
    v_exp_f32 v192, v192
    v_exp_f32 v193, v193
    v_mfma_f32_32x32x8_bf16 v[204:219], v[246:247], v[46:47], 0
    v_exp_f32 v194, v194
    v_exp_f32 v195, v195
    v_exp_f32 v196, v196
    v_exp_f32 v197, v197
    v_mfma_f32_32x32x16_bf16 v[204:219], v[234:237], v[42:45], v[204:219]
    v_exp_f32 v198, v198
    v_exp_f32 v199, v199
    v_exp_f32 v200, v200
    v_exp_f32 v201, v201
    v_smfmac_f32_32x32x32_bf16 v[124:139], v[238:241], v[188:195], v2
    v_exp_f32 v202, v202
    v_exp_f32 v203, v203
    v_exp_f32 v204, v204
    v_exp_f32 v205, v205
    v_smfmac_f32_32x32x32_bf16 v[124:139], v[242:245], v[196:203], v2
    v_exp_f32 v206, v206
    v_exp_f32 v207, v207
    v_exp_f32 v208, v208
    v_exp_f32 v209, v209
    v_mfma_f32_32x32x8_bf16 v[188:203], v[246:247], v[52:53], 0
    v_exp_f32 v210, v210
    v_exp_f32 v211, v211
    v_exp_f32 v212, v212
    v_exp_f32 v213, v213
    v_mfma_f32_32x32x16_bf16 v[188:203], v[234:237], v[48:51], v[188:203]
    v_exp_f32 v214, v214
    v_exp_f32 v215, v215
    v_exp_f32 v216, v216
    v_exp_f32 v217, v217
    v_smfmac_f32_32x32x32_bf16 v[140:155], v[238:241], v[204:211], v2
    v_exp_f32 v218, v218
    v_exp_f32 v219, v219
    v_exp_f32 v188, v188
    v_exp_f32 v189, v189
    v_smfmac_f32_32x32x32_bf16 v[140:155], v[242:245], v[212:219], v2
    v_exp_f32 v190, v190
    v_exp_f32 v191, v191
    v_exp_f32 v192, v192
    v_exp_f32 v193, v193
    v_mfma_f32_32x32x8_bf16 v[204:219], v[246:247], v[58:59], 0
    v_exp_f32 v194, v194
    v_exp_f32 v195, v195
    v_exp_f32 v196, v196
    v_exp_f32 v197, v197
    v_mfma_f32_32x32x16_bf16 v[204:219], v[234:237], v[54:57], v[204:219]
    v_exp_f32 v198, v198
    v_exp_f32 v199, v199
    v_exp_f32 v200, v200
    v_exp_f32 v201, v201
    v_smfmac_f32_32x32x32_bf16 v[156:171], v[238:241], v[188:195], v2
    v_exp_f32 v202, v202
    v_exp_f32 v203, v203
    v_exp_f32 v204, v204
    v_exp_f32 v205, v205
    v_smfmac_f32_32x32x32_bf16 v[156:171], v[242:245], v[196:203], v2
    v_exp_f32 v206, v206
    v_exp_f32 v207, v207
    buffer_load_dwordx4 v[234:237], v9, s[24:27], s40 offen offset:0 sc1
    v_exp_f32 v208, v208
    v_exp_f32 v209, v209
    s_waitcnt vmcnt(3)
    v_mfma_f32_32x32x8_bf16 v[188:203], v[232:233], v[16:17], 0
    v_exp_f32 v210, v210
    v_exp_f32 v211, v211
    buffer_load_dwordx2 v[246:247], v11, s[24:27], s40 offen offset:3072 sc1
    v_exp_f32 v212, v212
    v_exp_f32 v213, v213
    v_mfma_f32_32x32x16_bf16 v[188:203], v[220:223], v[12:15], v[188:203]
    v_exp_f32 v214, v214
    v_exp_f32 v215, v215
    v_exp_f32 v216, v216
    v_exp_f32 v217, v217
    v_smfmac_f32_32x32x32_bf16 v[172:187], v[238:241], v[204:211], v2
    v_exp_f32 v218, v218
    v_exp_f32 v219, v219
    s_sub_u32 s43, s43, 1
    s_cmp_lg_u32 s43, 0
    s_cbranch_scc1 L_att_loop
    v_mov_b32 v252, -1
    v_mov_b32 v253, -1
    v_mov_b32 v254, -1
    v_mov_b32 v255, -1
    buffer_store_dwordx4 v[252:255], v6, s[24:27], s37 offen sc1
    buffer_store_dwordx4 v[252:255], v6, s[24:27], s37 offen offset:512 sc1
    s_mov_b32 exec_hi, 0
    buffer_store_dwordx4 v[252:255], v6, s[24:27], s37 offen offset:1024 sc1
    s_mov_b32 exec_hi, -1
    v_exp_f32 v188, v188
    v_exp_f32 v189, v189
    v_smfmac_f32_32x32x32_bf16 v[172:187], v[242:245], v[212:219], v2
    v_exp_f32 v190, v190
    v_exp_f32 v191, v191
    buffer_load_dwordx4 v[238:241], v9, s[24:27], s40 offen offset:1024 sc1
    v_exp_f32 v192, v192
    v_exp_f32 v193, v193
    v_mfma_f32_32x32x8_bf16 v[204:219], v[232:233], v[22:23], 0
    v_exp_f32 v194, v194
    v_exp_f32 v195, v195
    buffer_load_dwordx4 v[242:245], v9, s[24:27], s40 offen offset:2048 sc1
    s_add_u32 s40, s40, 7168
    s_cmp_eq_u32 s40, s42
    s_cselect_b32 s40, s41, s40
    v_exp_f32 v196, v196
    v_exp_f32 v197, v197
    v_mfma_f32_32x32x16_bf16 v[204:219], v[220:223], v[18:21], v[204:219]
    v_exp_f32 v198, v198
    v_exp_f32 v199, v199
    v_exp_f32 v200, v200
    v_exp_f32 v201, v201
    s_waitcnt vmcnt(8)
    v_smfmac_f32_32x32x32_bf16 v[60:75], v[224:227], v[188:195], v2
    v_exp_f32 v202, v202
    v_exp_f32 v203, v203
    v_exp_f32 v204, v204
    v_exp_f32 v205, v205
    s_waitcnt vmcnt(7)
    v_smfmac_f32_32x32x32_bf16 v[60:75], v[228:231], v[196:203], v2
    v_exp_f32 v206, v206
    v_exp_f32 v207, v207
    v_exp_f32 v208, v208
    v_exp_f32 v209, v209
    v_mfma_f32_32x32x8_bf16 v[188:203], v[232:233], v[28:29], 0
    v_exp_f32 v210, v210
    v_exp_f32 v211, v211
    v_exp_f32 v212, v212
    v_exp_f32 v213, v213
    v_mfma_f32_32x32x16_bf16 v[188:203], v[220:223], v[24:27], v[188:203]
    v_exp_f32 v214, v214
    v_exp_f32 v215, v215
    v_exp_f32 v216, v216
    v_exp_f32 v217, v217
    v_smfmac_f32_32x32x32_bf16 v[76:91], v[224:227], v[204:211], v2
    v_exp_f32 v218, v218
    v_exp_f32 v219, v219
    v_exp_f32 v188, v188
    v_exp_f32 v189, v189
    v_smfmac_f32_32x32x32_bf16 v[76:91], v[228:231], v[212:219], v2
    v_exp_f32 v190, v190
    v_exp_f32 v191, v191
    v_exp_f32 v192, v192
    v_exp_f32 v193, v193
    v_mfma_f32_32x32x8_bf16 v[204:219], v[232:233], v[34:35], 0
    v_exp_f32 v194, v194
    v_exp_f32 v195, v195
    v_exp_f32 v196, v196
    v_exp_f32 v197, v197
    v_mfma_f32_32x32x16_bf16 v[204:219], v[220:223], v[30:33], v[204:219]
    v_exp_f32 v198, v198
    v_exp_f32 v199, v199
    v_exp_f32 v200, v200
    v_exp_f32 v201, v201
    v_smfmac_f32_32x32x32_bf16 v[92:107], v[224:227], v[188:195], v2
    v_exp_f32 v202, v202
    v_exp_f32 v203, v203
    v_exp_f32 v204, v204
    v_exp_f32 v205, v205
    v_smfmac_f32_32x32x32_bf16 v[92:107], v[228:231], v[196:203], v2
    v_exp_f32 v206, v206
    v_exp_f32 v207, v207
    v_exp_f32 v208, v208
    v_exp_f32 v209, v209
    v_mfma_f32_32x32x8_bf16 v[188:203], v[232:233], v[40:41], 0
    v_exp_f32 v210, v210
    v_exp_f32 v211, v211
    v_exp_f32 v212, v212
    v_exp_f32 v213, v213
    v_mfma_f32_32x32x16_bf16 v[188:203], v[220:223], v[36:39], v[188:203]
    v_exp_f32 v214, v214
    v_exp_f32 v215, v215
    v_exp_f32 v216, v216
    v_exp_f32 v217, v217
    v_smfmac_f32_32x32x32_bf16 v[108:123], v[224:227], v[204:211], v2
    v_exp_f32 v218, v218
    v_exp_f32 v219, v219
    v_exp_f32 v188, v188
    v_exp_f32 v189, v189
    v_smfmac_f32_32x32x32_bf16 v[108:123], v[228:231], v[212:219], v2
    v_exp_f32 v190, v190
    v_exp_f32 v191, v191
    v_exp_f32 v192, v192
    v_exp_f32 v193, v193
    v_mfma_f32_32x32x8_bf16 v[204:219], v[232:233], v[46:47], 0
    v_exp_f32 v194, v194
    v_exp_f32 v195, v195
    v_exp_f32 v196, v196
    v_exp_f32 v197, v197
    v_mfma_f32_32x32x16_bf16 v[204:219], v[220:223], v[42:45], v[204:219]
    v_exp_f32 v198, v198
    v_exp_f32 v199, v199
    v_exp_f32 v200, v200
    v_exp_f32 v201, v201
    v_smfmac_f32_32x32x32_bf16 v[124:139], v[224:227], v[188:195], v2
    v_exp_f32 v202, v202
    v_exp_f32 v203, v203
    v_exp_f32 v204, v204
    v_exp_f32 v205, v205
    v_smfmac_f32_32x32x32_bf16 v[124:139], v[228:231], v[196:203], v2
    v_exp_f32 v206, v206
    v_exp_f32 v207, v207
    v_exp_f32 v208, v208
    v_exp_f32 v209, v209
    v_mfma_f32_32x32x8_bf16 v[188:203], v[232:233], v[52:53], 0
    v_exp_f32 v210, v210
    v_exp_f32 v211, v211
    v_exp_f32 v212, v212
    v_exp_f32 v213, v213
    v_mfma_f32_32x32x16_bf16 v[188:203], v[220:223], v[48:51], v[188:203]
    v_exp_f32 v214, v214
    v_exp_f32 v215, v215
    v_exp_f32 v216, v216
    v_exp_f32 v217, v217
    v_smfmac_f32_32x32x32_bf16 v[140:155], v[224:227], v[204:211], v2
    v_exp_f32 v218, v218
    v_exp_f32 v219, v219
    v_exp_f32 v188, v188
    ds_read_b32 v3, v4 offset:16
    v_exp_f32 v189, v189
    v_smfmac_f32_32x32x32_bf16 v[140:155], v[228:231], v[212:219], v2
    v_exp_f32 v190, v190
    v_exp_f32 v191, v191
    v_exp_f32 v192, v192
    v_exp_f32 v193, v193
    v_mfma_f32_32x32x8_bf16 v[204:219], v[232:233], v[58:59], 0
    v_exp_f32 v194, v194
    v_exp_f32 v195, v195
    v_exp_f32 v196, v196
    v_exp_f32 v197, v197
    v_mfma_f32_32x32x16_bf16 v[204:219], v[220:223], v[54:57], v[204:219]
    v_exp_f32 v198, v198
    v_exp_f32 v199, v199
    v_exp_f32 v200, v200
    v_exp_f32 v201, v201
    v_smfmac_f32_32x32x32_bf16 v[156:171], v[224:227], v[188:195], v2
    v_exp_f32 v202, v202
    v_exp_f32 v203, v203
    v_exp_f32 v204, v204
    s_waitcnt lgkmcnt(0)
    v_readfirstlane_b32 s33, v3
    v_exp_f32 v205, v205
    v_smfmac_f32_32x32x32_bf16 v[156:171], v[228:231], v[196:203], v2
    v_exp_f32 v206, v206
    s_cmp_lt_u32 s33, 8
    s_cbranch_scc1 L_att_w
L_att_wb:
    v_exp_f32 v207, v207
    v_exp_f32 v208, v208
    v_exp_f32 v209, v209
    s_waitcnt vmcnt(5)
    v_mfma_f32_32x32x8_bf16 v[188:203], v[246:247], v[16:17], 0
    v_exp_f32 v210, v210
    v_exp_f32 v211, v211
    v_exp_f32 v212, v212
    v_exp_f32 v213, v213
    v_mfma_f32_32x32x16_bf16 v[188:203], v[234:237], v[12:15], v[188:203]
    v_exp_f32 v214, v214
    v_exp_f32 v215, v215
    v_exp_f32 v216, v216
    v_exp_f32 v217, v217
    v_smfmac_f32_32x32x32_bf16 v[172:187], v[224:227], v[204:211], v2
    v_exp_f32 v218, v218
    v_exp_f32 v219, v219
    v_exp_f32 v188, v188
    v_exp_f32 v189, v189
    v_smfmac_f32_32x32x32_bf16 v[172:187], v[228:231], v[212:219], v2
    v_exp_f32 v190, v190
    v_exp_f32 v191, v191
    v_exp_f32 v192, v192
    v_exp_f32 v193, v193
    v_mfma_f32_32x32x8_bf16 v[204:219], v[246:247], v[22:23], 0
    v_exp_f32 v194, v194
    v_exp_f32 v195, v195
    v_exp_f32 v196, v196
    v_exp_f32 v197, v197
    v_mfma_f32_32x32x16_bf16 v[204:219], v[234:237], v[18:21], v[204:219]
    v_exp_f32 v198, v198
    v_exp_f32 v199, v199
    v_exp_f32 v200, v200
    v_exp_f32 v201, v201
    s_waitcnt vmcnt(1)
    v_smfmac_f32_32x32x32_bf16 v[60:75], v[238:241], v[188:195], v2
    v_exp_f32 v202, v202
    v_exp_f32 v203, v203
    v_exp_f32 v204, v204
    v_exp_f32 v205, v205
    s_waitcnt vmcnt(0)
    v_smfmac_f32_32x32x32_bf16 v[60:75], v[242:245], v[196:203], v2
    v_exp_f32 v206, v206
    v_exp_f32 v207, v207
    v_exp_f32 v208, v208
    v_exp_f32 v209, v209
    v_mfma_f32_32x32x8_bf16 v[188:203], v[246:247], v[28:29], 0
    v_exp_f32 v210, v210
    v_exp_f32 v211, v211
    v_exp_f32 v212, v212
    v_exp_f32 v213, v213
    v_mfma_f32_32x32x16_bf16 v[188:203], v[234:237], v[24:27], v[188:203]
    v_exp_f32 v214, v214
    v_exp_f32 v215, v215
    v_exp_f32 v216, v216
    v_exp_f32 v217, v217
    v_smfmac_f32_32x32x32_bf16 v[76:91], v[238:241], v[204:211], v2
    v_exp_f32 v218, v218
    v_exp_f32 v219, v219
    v_exp_f32 v188, v188
    ds_write_b128 v248, v[60:63] offset:0
    v_exp_f32 v189, v189
    v_smfmac_f32_32x32x32_bf16 v[76:91], v[242:245], v[212:219], v2
    v_exp_f32 v190, v190
    v_exp_f32 v191, v191
    v_exp_f32 v192, v192
    ds_write_b128 v248, v[64:67] offset:1024
    v_exp_f32 v193, v193
    v_mfma_f32_32x32x8_bf16 v[204:219], v[246:247], v[34:35], 0
    v_exp_f32 v194, v194
    v_exp_f32 v195, v195
    v_exp_f32 v196, v196
    ds_write_b128 v248, v[68:71] offset:2048
    v_exp_f32 v197, v197
    v_mfma_f32_32x32x16_bf16 v[204:219], v[234:237], v[30:33], v[204:219]
    v_exp_f32 v198, v198
    v_exp_f32 v199, v199
    v_exp_f32 v200, v200
    ds_write_b32 v249, v72 offset:3072
    v_exp_f32 v201, v201
    v_smfmac_f32_32x32x32_bf16 v[92:107], v[238:241], v[188:195], v2
    v_exp_f32 v202, v202
    v_exp_f32 v203, v203
    v_exp_f32 v204, v204
    ds_write_b128 v248, v[76:79] offset:3328
    v_exp_f32 v205, v205
    v_smfmac_f32_32x32x32_bf16 v[92:107], v[242:245], v[196:203], v2
    v_exp_f32 v206, v206
    v_exp_f32 v207, v207
    v_minimum3_f32 v250, v72, v88, v72
    v_exp_f32 v208, v208
    ds_write_b128 v248, v[80:83] offset:4352
    v_exp_f32 v209, v209
    v_mfma_f32_32x32x8_bf16 v[188:203], v[246:247], v[40:41], 0
    v_exp_f32 v210, v210
    v_exp_f32 v211, v211
    v_maximum3_f32 v251, v72, v88, v72
    v_exp_f32 v212, v212
    ds_write_b128 v248, v[84:87] offset:5376
    v_exp_f32 v213, v213
    v_mfma_f32_32x32x16_bf16 v[188:203], v[234:237], v[36:39], v[188:203]
    v_exp_f32 v214, v214
    v_exp_f32 v215, v215
    v_maximum3_f32 v251, |v68|, |v69|, v251
    v_exp_f32 v216, v216
    ds_write_b32 v249, v88 offset:6400
    v_exp_f32 v217, v217
    v_smfmac_f32_32x32x32_bf16 v[108:123], v[238:241], v[204:211], v2
    v_exp_f32 v218, v218
    v_maximum3_f32 v251, |v84|, |v85|, v251
    v_exp_f32 v219, v219
    v_exp_f32 v188, v188
    ds_write_b128 v248, v[92:95] offset:6656
    v_exp_f32 v189, v189
    v_smfmac_f32_32x32x32_bf16 v[108:123], v[242:245], v[212:219], v2
    v_exp_f32 v190, v190
    v_exp_f32 v191, v191
    v_exp_f32 v192, v192
    ds_write_b128 v248, v[96:99] offset:7680
    v_exp_f32 v193, v193
    v_mfma_f32_32x32x8_bf16 v[204:219], v[246:247], v[46:47], 0
    v_exp_f32 v194, v194
    v_exp_f32 v195, v195
    v_exp_f32 v196, v196
    ds_write_b128 v248, v[100:103] offset:8704
    v_exp_f32 v197, v197
    v_mfma_f32_32x32x16_bf16 v[204:219], v[234:237], v[42:45], v[204:219]
    v_exp_f32 v198, v198
    v_exp_f32 v199, v199
    v_exp_f32 v200, v200
    ds_write_b32 v249, v104 offset:9728
    v_exp_f32 v201, v201
    v_smfmac_f32_32x32x32_bf16 v[124:139], v[238:241], v[188:195], v2
    v_exp_f32 v202, v202
    v_exp_f32 v203, v203
    v_exp_f32 v204, v204
    ds_write_b128 v248, v[108:111] offset:9984
    v_exp_f32 v205, v205
    v_smfmac_f32_32x32x32_bf16 v[124:139], v[242:245], v[196:203], v2
    v_exp_f32 v206, v206
    v_exp_f32 v207, v207
    v_minimum3_f32 v250, v104, v120, v250
    v_exp_f32 v208, v208
    ds_write_b128 v248, v[112:115] offset:11008
    v_exp_f32 v209, v209
    v_mfma_f32_32x32x8_bf16 v[188:203], v[246:247], v[52:53], 0
    v_exp_f32 v210, v210
    v_exp_f32 v211, v211
    v_maximum3_f32 v251, v104, v120, v251
    v_exp_f32 v212, v212
    ds_write_b128 v248, v[116:119] offset:12032
    v_exp_f32 v213, v213
    v_mfma_f32_32x32x16_bf16 v[188:203], v[234:237], v[48:51], v[188:203]
    v_exp_f32 v214, v214
    v_exp_f32 v215, v215
    v_maximum3_f32 v251, |v100|, |v101|, v251
    v_exp_f32 v216, v216
    ds_write_b32 v249, v120 offset:13056
    v_exp_f32 v217, v217
    v_smfmac_f32_32x32x32_bf16 v[140:155], v[238:241], v[204:211], v2
    v_exp_f32 v218, v218
    v_maximum3_f32 v251, |v116|, |v117|, v251
    v_exp_f32 v219, v219
    v_exp_f32 v188, v188
    ds_write_b128 v248, v[124:127] offset:13312
    v_exp_f32 v189, v189
    v_smfmac_f32_32x32x32_bf16 v[140:155], v[242:245], v[212:219], v2
    v_exp_f32 v190, v190
    v_exp_f32 v191, v191
    v_exp_f32 v192, v192
    ds_write_b128 v248, v[128:131] offset:14336
    v_exp_f32 v193, v193
    v_mfma_f32_32x32x8_bf16 v[204:219], v[246:247], v[58:59], 0
    v_exp_f32 v194, v194
    v_exp_f32 v195, v195
    v_exp_f32 v196, v196
    ds_write_b128 v248, v[132:135] offset:15360
    v_exp_f32 v197, v197
    v_mfma_f32_32x32x16_bf16 v[204:219], v[234:237], v[54:57], v[204:219]
    v_exp_f32 v198, v198
    v_exp_f32 v199, v199
    v_exp_f32 v200, v200
    ds_write_b32 v249, v136 offset:16384
    v_exp_f32 v201, v201
    v_smfmac_f32_32x32x32_bf16 v[156:171], v[238:241], v[188:195], v2
    v_exp_f32 v202, v202
    v_exp_f32 v203, v203
    v_exp_f32 v204, v204
    ds_write_b128 v248, v[140:143] offset:16640
    v_exp_f32 v205, v205
    v_smfmac_f32_32x32x32_bf16 v[156:171], v[242:245], v[196:203], v2
    v_exp_f32 v206, v206
    v_exp_f32 v207, v207
    v_minimum3_f32 v250, v136, v152, v250
    v_exp_f32 v208, v208
    ds_write_b128 v248, v[144:147] offset:17664
    v_exp_f32 v209, v209
    v_exp_f32 v210, v210
    v_exp_f32 v211, v211
    v_maximum3_f32 v251, v136, v152, v251
    v_exp_f32 v212, v212
    ds_write_b128 v248, v[148:151] offset:18688
    v_exp_f32 v213, v213
    v_exp_f32 v214, v214
    v_exp_f32 v215, v215
    v_maximum3_f32 v251, |v132|, |v133|, v251
    v_exp_f32 v216, v216
    ds_write_b32 v249, v152 offset:19712
    v_exp_f32 v217, v217
    v_smfmac_f32_32x32x32_bf16 v[172:187], v[238:241], v[204:211], v2
    v_exp_f32 v218, v218
    v_maximum3_f32 v251, |v148|, |v149|, v251
    v_exp_f32 v219, v219
    s_lshl_b32 s33, s28, 2
    v_mov_b32 v188, s33
    v_smfmac_f32_32x32x32_bf16 v[172:187], v[242:245], v[212:219], v2
    v_add_u32 v193, s56, v8
    v_lshl_add_u32 v197, v1, 2, s56
    v_add_u32 v194, s57, v8
    v_lshl_add_u32 v198, v1, 2, s57
    v_add_u32 v195, s58, v8
    v_lshl_add_u32 v199, v1, 2, s58
    v_mov_b32 v7, 1
    s_nop 4
    v_minimum3_f32 v250, v168, v184, v250
    v_maximum3_f32 v251, v168, v184, v251
    v_maximum3_f32 v251, |v164|, |v165|, v251
    v_maximum3_f32 v251, |v180|, |v181|, v251
    v_cmp_nle_f32 s[50:51], s47, v250
    v_cmp_nge_f32 s[52:53], s48, v251
    s_nop 1
    s_or_b64 s[50:51], s[50:51], s[52:53]
    s_cselect_b32 s33, 1, 0
    s_andn2_b32 s33, s33, s46
    v_mov_b32 v3, s33
    ds_write_b32 v188, v3 offset:0
    s_waitcnt vmcnt(0) lgkmcnt(0)
    s_barrier
    ds_read_b128 v[200:203], v4
    ds_read_b32 v72, v197 offset:3072
    ds_read_b32 v104, v198 offset:3072
    ds_read_b32 v136, v199 offset:3072
    ds_read_b128 v[60:63], v193 offset:0
    ds_read_b128 v[92:95], v194 offset:0
    ds_read_b128 v[124:127], v195 offset:0
    ds_read_b128 v[64:67], v193 offset:1024
    ds_read_b128 v[96:99], v194 offset:1024
    ds_read_b128 v[128:131], v195 offset:1024
    ds_read_b128 v[68:71], v193 offset:2048
    ds_read_b128 v[100:103], v194 offset:2048
    ds_read_b128 v[132:135], v195 offset:2048
    s_waitcnt lgkmcnt(12)
    v_or3_b32 v3, v200, v201, v202
    v_or_b32 v3, v3, v203
    ds_read_b32 v88, v197 offset:6400
    v_readfirstlane_b32 s34, v3
    ds_read_b32 v120, v198 offset:6400
    ds_read_b32 v152, v199 offset:6400
    ds_read_b128 v[76:79], v193 offset:3328
    ds_read_b128 v[108:111], v194 offset:3328
    ds_read_b128 v[140:143], v195 offset:3328
    ds_read_b128 v[80:83], v193 offset:4352
    ds_read_b128 v[112:115], v194 offset:4352
    ds_read_b128 v[144:147], v195 offset:4352
    ds_read_b128 v[84:87], v193 offset:5376
    ds_read_b128 v[116:119], v194 offset:5376
    ds_read_b128 v[148:151], v195 offset:5376
    s_cmp_lg_u32 s34, 0
    s_cbranch_scc1 L_att_slow
    s_waitcnt lgkmcnt(15)
    v_add_f32 v72, v72, v168
    v_add_f32 v136, v136, v104
    v_add_f32 v72, v72, v136
    v_rcp_f32 v72, v72
    v_pk_add_f32 v[60:61], v[60:61], v[156:157]
    v_pk_add_f32 v[62:63], v[62:63], v[158:159]
    v_pk_add_f32 v[124:125], v[124:125], v[92:93]
    v_pk_add_f32 v[126:127], v[126:127], v[94:95]
    v_pk_add_f32 v[60:61], v[60:61], v[124:125]
    v_pk_add_f32 v[62:63], v[62:63], v[126:127]
    v_pk_mul_f32 v[60:61], v[60:61], v[72:73] op_sel_hi:[1,0]
    v_pk_mul_f32 v[62:63], v[62:63], v[72:73] op_sel_hi:[1,0]
    v_cvt_pk_bf16_f32 v204, v60, v61
    v_cvt_pk_bf16_f32 v205, v62, v63
    v_pk_add_f32 v[64:65], v[64:65], v[160:161]
    v_pk_add_f32 v[66:67], v[66:67], v[162:163]
    v_pk_add_f32 v[128:129], v[128:129], v[96:97]
    v_pk_add_f32 v[130:131], v[130:131], v[98:99]
    v_pk_add_f32 v[64:65], v[64:65], v[128:129]
    v_pk_add_f32 v[66:67], v[66:67], v[130:131]
    v_pk_mul_f32 v[64:65], v[64:65], v[72:73] op_sel_hi:[1,0]
    v_pk_mul_f32 v[66:67], v[66:67], v[72:73] op_sel_hi:[1,0]
    v_cvt_pk_bf16_f32 v206, v64, v65
    v_cvt_pk_bf16_f32 v207, v66, v67
    s_waitcnt lgkmcnt(14)
    v_pk_add_f32 v[68:69], v[68:69], v[164:165]
    v_pk_add_f32 v[70:71], v[70:71], v[166:167]
    s_waitcnt lgkmcnt(12)
    v_pk_add_f32 v[132:133], v[132:133], v[100:101]
    v_pk_add_f32 v[134:135], v[134:135], v[102:103]
    v_pk_add_f32 v[68:69], v[68:69], v[132:133]
    v_pk_add_f32 v[70:71], v[70:71], v[134:135]
    v_pk_mul_f32 v[68:69], v[68:69], v[72:73] op_sel_hi:[1,0]
    v_pk_mul_f32 v[70:71], v[70:71], v[72:73] op_sel_hi:[1,0]
    v_permlane32_swap_b32 v204, v206
    v_permlane32_swap_b32 v205, v207
    v_cvt_pk_bf16_f32 v208, v68, v69
    v_cvt_pk_bf16_f32 v209, v70, v71
    buffer_store_dwordx4 v[204:207], v6, s[24:27], s37 offen sc1
    s_waitcnt lgkmcnt(11)
    v_add_f32 v88, v88, v184
    s_waitcnt lgkmcnt(9)
    v_add_f32 v152, v152, v120
    v_add_f32 v88, v88, v152
    v_rcp_f32 v88, v88
    s_waitcnt lgkmcnt(8)
    v_pk_add_f32 v[76:77], v[76:77], v[172:173]
    v_pk_add_f32 v[78:79], v[78:79], v[174:175]
    s_waitcnt lgkmcnt(6)
    v_pk_add_f32 v[140:141], v[140:141], v[108:109]
    v_pk_add_f32 v[142:143], v[142:143], v[110:111]
    v_pk_add_f32 v[76:77], v[76:77], v[140:141]
    v_pk_add_f32 v[78:79], v[78:79], v[142:143]
    v_pk_mul_f32 v[76:77], v[76:77], v[88:89] op_sel_hi:[1,0]
    v_pk_mul_f32 v[78:79], v[78:79], v[88:89] op_sel_hi:[1,0]
    v_cvt_pk_bf16_f32 v210, v76, v77
    v_cvt_pk_bf16_f32 v211, v78, v79
    s_waitcnt lgkmcnt(5)
    v_pk_add_f32 v[80:81], v[80:81], v[176:177]
    v_pk_add_f32 v[82:83], v[82:83], v[178:179]
    s_waitcnt lgkmcnt(3)
    v_pk_add_f32 v[144:145], v[144:145], v[112:113]
    v_pk_add_f32 v[146:147], v[146:147], v[114:115]
    v_pk_add_f32 v[80:81], v[80:81], v[144:145]
    v_pk_add_f32 v[82:83], v[82:83], v[146:147]
    v_pk_mul_f32 v[80:81], v[80:81], v[88:89] op_sel_hi:[1,0]
    v_pk_mul_f32 v[82:83], v[82:83], v[88:89] op_sel_hi:[1,0]
    v_cvt_pk_bf16_f32 v216, v80, v81
    v_cvt_pk_bf16_f32 v217, v82, v83
    s_waitcnt lgkmcnt(2)
    v_pk_add_f32 v[84:85], v[84:85], v[180:181]
    v_pk_add_f32 v[86:87], v[86:87], v[182:183]
    s_waitcnt lgkmcnt(0)
    v_pk_add_f32 v[148:149], v[148:149], v[116:117]
    v_pk_add_f32 v[150:151], v[150:151], v[118:119]
    v_pk_add_f32 v[84:85], v[84:85], v[148:149]
    v_pk_add_f32 v[86:87], v[86:87], v[150:151]
    v_pk_mul_f32 v[84:85], v[84:85], v[88:89] op_sel_hi:[1,0]
    v_pk_mul_f32 v[86:87], v[86:87], v[88:89] op_sel_hi:[1,0]
    v_permlane32_swap_b32 v210, v216
    v_permlane32_swap_b32 v211, v217
    v_cvt_pk_bf16_f32 v214, v84, v85
    v_cvt_pk_bf16_f32 v215, v86, v87
    v_permlane32_swap_b32 v208, v216
    v_permlane32_swap_b32 v209, v217
    s_nop 1
    v_permlane32_swap_b32 v216, v212
    v_permlane32_swap_b32 v217, v213
    buffer_store_dwordx4 v[208:211], v6, s[24:27], s37 offen offset:512 sc1
    s_mov_b32 exec_hi, 0
    buffer_store_dwordx4 v[212:215], v6, s[24:27], s37 offen offset:1024 sc1
    s_mov_b64 exec, 1
    buffer_store_dword v7, v4, s[24:27], s39 offen sc1
    s_barrier
    s_endpgm
L_att_w:
    ds_read_b32 v3, v4 offset:16
    s_waitcnt lgkmcnt(0)
    v_readfirstlane_b32 s33, v3
    s_nop 0
    s_cmp_lt_u32 s33, 8
    s_cbranch_scc1 L_att_w
    s_branch L_att_wb
L_att_slow:
    s_waitcnt vmcnt(0) lgkmcnt(0)
    s_barrier
    v_mov_b32 v60, 0xff800000
    v_mov_b32 v61, 0xff800000
    v_mov_b32 v62, 0xff800000
    v_mov_b32 v63, 0xff800000
    v_mov_b32 v64, 0xff800000
    v_mov_b32 v65, 0xff800000
    v_mov_b32 v66, 0xff800000
    v_mov_b32 v67, 0xff800000
    s_mov_b32 s44, 5242880
    s_mov_b32 s45, 64
L_att_fb:
    buffer_load_dwordx4 v[68:71], v8, s[24:27], s44 offen sc1
    buffer_load_dwordx2 v[72:73], v10, s[24:27], s44 offen offset:3072 sc1
    s_waitcnt vmcnt(0)
    v_mfma_f32_32x32x16_bf16 v[188:203], v[68:71], v[12:15], 0
    v_mfma_f32_32x32x8_bf16 v[188:203], v[72:73], v[16:17], v[188:203]
    s_nop 15
    v_max3_f32 v60, v188, v189, v60
    v_max3_f32 v60, v190, v191, v60
    v_max3_f32 v60, v192, v193, v60
    v_max3_f32 v60, v194, v195, v60
    v_max3_f32 v60, v196, v197, v60
    v_max3_f32 v60, v198, v199, v60
    v_max3_f32 v60, v200, v201, v60
    v_max3_f32 v60, v202, v203, v60
    v_mfma_f32_32x32x16_bf16 v[204:219], v[68:71], v[18:21], 0
    v_mfma_f32_32x32x8_bf16 v[204:219], v[72:73], v[22:23], v[204:219]
    s_nop 15
    v_max3_f32 v61, v204, v205, v61
    v_max3_f32 v61, v206, v207, v61
    v_max3_f32 v61, v208, v209, v61
    v_max3_f32 v61, v210, v211, v61
    v_max3_f32 v61, v212, v213, v61
    v_max3_f32 v61, v214, v215, v61
    v_max3_f32 v61, v216, v217, v61
    v_max3_f32 v61, v218, v219, v61
    v_mfma_f32_32x32x16_bf16 v[188:203], v[68:71], v[24:27], 0
    v_mfma_f32_32x32x8_bf16 v[188:203], v[72:73], v[28:29], v[188:203]
    s_nop 15
    v_max3_f32 v62, v188, v189, v62
    v_max3_f32 v62, v190, v191, v62
    v_max3_f32 v62, v192, v193, v62
    v_max3_f32 v62, v194, v195, v62
    v_max3_f32 v62, v196, v197, v62
    v_max3_f32 v62, v198, v199, v62
    v_max3_f32 v62, v200, v201, v62
    v_max3_f32 v62, v202, v203, v62
    v_mfma_f32_32x32x16_bf16 v[204:219], v[68:71], v[30:33], 0
    v_mfma_f32_32x32x8_bf16 v[204:219], v[72:73], v[34:35], v[204:219]
    s_nop 15
    v_max3_f32 v63, v204, v205, v63
    v_max3_f32 v63, v206, v207, v63
    v_max3_f32 v63, v208, v209, v63
    v_max3_f32 v63, v210, v211, v63
    v_max3_f32 v63, v212, v213, v63
    v_max3_f32 v63, v214, v215, v63
    v_max3_f32 v63, v216, v217, v63
    v_max3_f32 v63, v218, v219, v63
    v_mfma_f32_32x32x16_bf16 v[188:203], v[68:71], v[36:39], 0
    v_mfma_f32_32x32x8_bf16 v[188:203], v[72:73], v[40:41], v[188:203]
    s_nop 15
    v_max3_f32 v64, v188, v189, v64
    v_max3_f32 v64, v190, v191, v64
    v_max3_f32 v64, v192, v193, v64
    v_max3_f32 v64, v194, v195, v64
    v_max3_f32 v64, v196, v197, v64
    v_max3_f32 v64, v198, v199, v64
    v_max3_f32 v64, v200, v201, v64
    v_max3_f32 v64, v202, v203, v64
    v_mfma_f32_32x32x16_bf16 v[204:219], v[68:71], v[42:45], 0
    v_mfma_f32_32x32x8_bf16 v[204:219], v[72:73], v[46:47], v[204:219]
    s_nop 15
    v_max3_f32 v65, v204, v205, v65
    v_max3_f32 v65, v206, v207, v65
    v_max3_f32 v65, v208, v209, v65
    v_max3_f32 v65, v210, v211, v65
    v_max3_f32 v65, v212, v213, v65
    v_max3_f32 v65, v214, v215, v65
    v_max3_f32 v65, v216, v217, v65
    v_max3_f32 v65, v218, v219, v65
    v_mfma_f32_32x32x16_bf16 v[188:203], v[68:71], v[48:51], 0
    v_mfma_f32_32x32x8_bf16 v[188:203], v[72:73], v[52:53], v[188:203]
    s_nop 15
    v_max3_f32 v66, v188, v189, v66
    v_max3_f32 v66, v190, v191, v66
    v_max3_f32 v66, v192, v193, v66
    v_max3_f32 v66, v194, v195, v66
    v_max3_f32 v66, v196, v197, v66
    v_max3_f32 v66, v198, v199, v66
    v_max3_f32 v66, v200, v201, v66
    v_max3_f32 v66, v202, v203, v66
    v_mfma_f32_32x32x16_bf16 v[204:219], v[68:71], v[54:57], 0
    v_mfma_f32_32x32x8_bf16 v[204:219], v[72:73], v[58:59], v[204:219]
    s_nop 15
    v_max3_f32 v67, v204, v205, v67
    v_max3_f32 v67, v206, v207, v67
    v_max3_f32 v67, v208, v209, v67
    v_max3_f32 v67, v210, v211, v67
    v_max3_f32 v67, v212, v213, v67
    v_max3_f32 v67, v214, v215, v67
    v_max3_f32 v67, v216, v217, v67
    v_max3_f32 v67, v218, v219, v67
    s_add_u32 s44, s44, 3584
    s_sub_u32 s45, s45, 1
    s_cmp_lg_u32 s45, 0
    s_cbranch_scc1 L_att_fb
    buffer_load_dwordx2 v[232:233], v10, s[24:27], s40 offen offset:3072 sc1
    buffer_load_dwordx4 v[220:223], v8, s[24:27], s40 offen offset:0 sc1
    buffer_load_dwordx4 v[224:227], v8, s[24:27], s40 offen offset:1024 sc1
    buffer_load_dwordx4 v[228:231], v8, s[24:27], s40 offen offset:2048 sc1
    buffer_load_dwordx2 v[246:247], v11, s[24:27], s40 offen offset:3072 sc1
    buffer_load_dwordx4 v[234:237], v9, s[24:27], s40 offen offset:0 sc1
    v_cmp_eq_u32 vcc, 0, v5
    v_mov_b32 v3, v60
    s_nop 1
    v_permlane32_swap_b32 v60, v3
    s_nop 1
    v_max_f32 v60, v60, v3
    v_sub_f32 v3, 0, v60
    v_and_b32 v76, 0xffff0000, v3
    v_sub_f32 v3, v3, v76
    v_and_b32 v7, 0xffff0000, v3
    v_sub_f32 v3, v3, v7
    v_lshrrev_b32 v3, 16, v3
    v_lshrrev_b32 v76, 16, v76
    v_or_b32 v76, v76, v7
    v_cndmask_b32 v16, v76, v16, vcc
    v_cndmask_b32 v17, v3, v17, vcc
    v_mov_b32 v3, v61
    s_nop 1
    v_permlane32_swap_b32 v61, v3
    s_nop 1
    v_max_f32 v61, v61, v3
    v_sub_f32 v3, 0, v61
    v_and_b32 v76, 0xffff0000, v3
    v_sub_f32 v3, v3, v76
    v_and_b32 v7, 0xffff0000, v3
    v_sub_f32 v3, v3, v7
    v_lshrrev_b32 v3, 16, v3
    v_lshrrev_b32 v76, 16, v76
    v_or_b32 v76, v76, v7
    v_cndmask_b32 v22, v76, v22, vcc
    v_cndmask_b32 v23, v3, v23, vcc
    v_mov_b32 v3, v62
    s_nop 1
    v_permlane32_swap_b32 v62, v3
    s_nop 1
    v_max_f32 v62, v62, v3
    v_sub_f32 v3, 0, v62
    v_and_b32 v76, 0xffff0000, v3
    v_sub_f32 v3, v3, v76
    v_and_b32 v7, 0xffff0000, v3
    v_sub_f32 v3, v3, v7
    v_lshrrev_b32 v3, 16, v3
    v_lshrrev_b32 v76, 16, v76
    v_or_b32 v76, v76, v7
    v_cndmask_b32 v28, v76, v28, vcc
    v_cndmask_b32 v29, v3, v29, vcc
    v_mov_b32 v3, v63
    s_nop 1
    v_permlane32_swap_b32 v63, v3
    s_nop 1
    v_max_f32 v63, v63, v3
    v_sub_f32 v3, 0, v63
    v_and_b32 v76, 0xffff0000, v3
    v_sub_f32 v3, v3, v76
    v_and_b32 v7, 0xffff0000, v3
    v_sub_f32 v3, v3, v7
    v_lshrrev_b32 v3, 16, v3
    v_lshrrev_b32 v76, 16, v76
    v_or_b32 v76, v76, v7
    v_cndmask_b32 v34, v76, v34, vcc
    v_cndmask_b32 v35, v3, v35, vcc
    v_mov_b32 v3, v64
    s_nop 1
    v_permlane32_swap_b32 v64, v3
    s_nop 1
    v_max_f32 v64, v64, v3
    v_sub_f32 v3, 0, v64
    v_and_b32 v76, 0xffff0000, v3
    v_sub_f32 v3, v3, v76
    v_and_b32 v7, 0xffff0000, v3
    v_sub_f32 v3, v3, v7
    v_lshrrev_b32 v3, 16, v3
    v_lshrrev_b32 v76, 16, v76
    v_or_b32 v76, v76, v7
    v_cndmask_b32 v40, v76, v40, vcc
    v_cndmask_b32 v41, v3, v41, vcc
    v_mov_b32 v3, v65
    s_nop 1
    v_permlane32_swap_b32 v65, v3
    s_nop 1
    v_max_f32 v65, v65, v3
    v_sub_f32 v3, 0, v65
    v_and_b32 v76, 0xffff0000, v3
    v_sub_f32 v3, v3, v76
    v_and_b32 v7, 0xffff0000, v3
    v_sub_f32 v3, v3, v7
    v_lshrrev_b32 v3, 16, v3
    v_lshrrev_b32 v76, 16, v76
    v_or_b32 v76, v76, v7
    v_cndmask_b32 v46, v76, v46, vcc
    v_cndmask_b32 v47, v3, v47, vcc
    v_mov_b32 v3, v66
    s_nop 1
    v_permlane32_swap_b32 v66, v3
    s_nop 1
    v_max_f32 v66, v66, v3
    v_sub_f32 v3, 0, v66
    v_and_b32 v76, 0xffff0000, v3
    v_sub_f32 v3, v3, v76
    v_and_b32 v7, 0xffff0000, v3
    v_sub_f32 v3, v3, v7
    v_lshrrev_b32 v3, 16, v3
    v_lshrrev_b32 v76, 16, v76
    v_or_b32 v76, v76, v7
    v_cndmask_b32 v52, v76, v52, vcc
    v_cndmask_b32 v53, v3, v53, vcc
    v_mov_b32 v3, v67
    s_nop 1
    v_permlane32_swap_b32 v67, v3
    s_nop 1
    v_max_f32 v67, v67, v3
    v_sub_f32 v3, 0, v67
    v_and_b32 v76, 0xffff0000, v3
    v_sub_f32 v3, v3, v76
    v_and_b32 v7, 0xffff0000, v3
    v_sub_f32 v3, v3, v7
    v_lshrrev_b32 v3, 16, v3
    v_lshrrev_b32 v76, 16, v76
    v_or_b32 v76, v76, v7
    v_cndmask_b32 v58, v76, v58, vcc
    v_cndmask_b32 v59, v3, v59, vcc
    s_mov_b32 s46, 1
    v_mov_b64 v[60:61], 0
    v_mov_b64 v[62:63], 0
    v_mov_b64 v[64:65], 0
    v_mov_b64 v[66:67], 0
    v_mov_b64 v[68:69], 0
    v_mov_b64 v[70:71], 0
    v_mov_b64 v[72:73], 0
    v_mov_b64 v[74:75], 0
    v_mov_b64 v[76:77], 0
    v_mov_b64 v[78:79], 0
    v_mov_b64 v[80:81], 0
    v_mov_b64 v[82:83], 0
    v_mov_b64 v[84:85], 0
    v_mov_b64 v[86:87], 0
    v_mov_b64 v[88:89], 0
    v_mov_b64 v[90:91], 0
    v_mov_b64 v[92:93], 0
    v_mov_b64 v[94:95], 0
    v_mov_b64 v[96:97], 0
    v_mov_b64 v[98:99], 0
    v_mov_b64 v[100:101], 0
    v_mov_b64 v[102:103], 0
    v_mov_b64 v[104:105], 0
    v_mov_b64 v[106:107], 0
    v_mov_b64 v[108:109], 0
    v_mov_b64 v[110:111], 0
    v_mov_b64 v[112:113], 0
    v_mov_b64 v[114:115], 0
    v_mov_b64 v[116:117], 0
    v_mov_b64 v[118:119], 0
    v_mov_b64 v[120:121], 0
    v_mov_b64 v[122:123], 0
    v_mov_b64 v[124:125], 0
    v_mov_b64 v[126:127], 0
    v_mov_b64 v[128:129], 0
    v_mov_b64 v[130:131], 0
    v_mov_b64 v[132:133], 0
    v_mov_b64 v[134:135], 0
    v_mov_b64 v[136:137], 0
    v_mov_b64 v[138:139], 0
    v_mov_b64 v[140:141], 0
    v_mov_b64 v[142:143], 0
    v_mov_b64 v[144:145], 0
    v_mov_b64 v[146:147], 0
    v_mov_b64 v[148:149], 0
    v_mov_b64 v[150:151], 0
    v_mov_b64 v[152:153], 0
    v_mov_b64 v[154:155], 0
    v_mov_b64 v[156:157], 0
    v_mov_b64 v[158:159], 0
    v_mov_b64 v[160:161], 0
    v_mov_b64 v[162:163], 0
    v_mov_b64 v[164:165], 0
    v_mov_b64 v[166:167], 0
    v_mov_b64 v[168:169], 0
    v_mov_b64 v[170:171], 0
    v_mov_b64 v[172:173], 0
    v_mov_b64 v[174:175], 0
    v_mov_b64 v[176:177], 0
    v_mov_b64 v[178:179], 0
    v_mov_b64 v[180:181], 0
    v_mov_b64 v[182:183], 0
    v_mov_b64 v[184:185], 0
    v_mov_b64 v[186:187], 0
    v_mov_b64 v[212:213], 0
    v_mov_b64 v[214:215], 0
    v_mov_b64 v[216:217], 0
    v_mov_b64 v[218:219], 0
    v_mov_b64 v[242:243], 0
    v_mov_b64 v[244:245], 0
    s_waitcnt vmcnt(0)
    s_branch L_att_start
L_k2_down:
    s_lshl_b32 s86, s29, 10
    s_add_u32 s87, s86, 5783680
    s_lshl_b32 s50, s30, 2
    s_add_u32 s86, s87, s50
    s_xor_b32 s88, s30, 4
    v_mov_b32 v166, 160000
    v_mov_b32 v17, 1
    s_waitcnt vmcnt(0)
    s_mov_b64 exec, 1
    ds_add_u32 v166, v17 offset:12
    s_mov_b64 exec, -1
    s_cmp_lg_u32 s28, 4
    s_cbranch_scc1 L_dn_nokv
    v_lshlrev_b32 v6, 10, v2
    v_lshl_add_u32 v6, v3, 3, v6
    s_mov_b32 s50, 5783552
    s_mov_b32 s52, 0x40000
L_dn_kv:
    buffer_load_dwordx2 v[8:9], v6, s[24:27], s50 offen sc1
    s_waitcnt vmcnt(0)
    v_min_u32 v8, v8, v9
    v_cmp_eq_u32 vcc, 0, v8
    s_sub_u32 s52, s52, 1
    s_cbranch_scc1 L_dn_kv_go
    s_nop 2
    s_cbranch_vccz L_dn_kv_go
    s_sleep 3
    s_branch L_dn_kv
L_dn_kv_go:
    ds_write_b32 v166, v17 offset:4
L_dn_nokv:
    s_bfe_u32 s29, s2, 0x20001
    s_lshl_b32 s29, s29, 3
    s_lshr_b32 s30, s2, 5
    s_add_u32 s29, s29, s30
    s_and_b32 s30, s2, 1
    s_lshl_b32 s30, s30, 2
    s_bfe_u32 s31, s2, 0x20003
    s_add_u32 s30, s30, s31
    v_mov_b32 v16, 0
    s_sub_u32 s31, s28, 4
    v_lshlrev_b32 v14, 4, v1
    v_add_u32 v15, 4096, v14
    s_add_u32 s50, s31, 0
    s_and_b32 s50, s50, 3
    s_mul_i32 s50, s50, 96256
    v_add_u32 v2, s50, v14
    s_add_u32 s50, s31, 1
    s_and_b32 s50, s50, 3
    s_mul_i32 s50, s50, 96256
    v_add_u32 v3, s50, v14
    s_add_u32 s50, s31, 2
    s_and_b32 s50, s50, 3
    s_mul_i32 s50, s50, 96256
    v_add_u32 v4, s50, v14
    s_add_u32 s50, s31, 3
    s_and_b32 s50, s50, 3
    s_mul_i32 s50, s50, 96256
    v_add_u32 v5, s50, v14
    s_mul_i32 s37, s29, 385024
    s_add_u32 s37, s37, 6291456
    s_add_u32 s49, s37, 55296
    s_lshl_b32 s38, s31, 10
    s_add_u32 s37, s37, s38
    s_mul_i32 s39, s30, 5120
    s_add_u32 s39, s39, 0
    s_mul_i32 s38, s31, 40960
    s_add_u32 s38, s38, s39
    s_add_u32 s39, s39, 2211840
    s_add_u32 s55, s49, 10240
    s_mov_b32 s58, s39
    s_waitcnt lgkmcnt(0)
    s_mul_i32 s33, s30, 160
    s_movk_i32 s34, 1280
    v_lshrrev_b32 v6, 4, v1
    v_and_b32 v7, 15, v1
    v_lshl_add_u32 v6, v6, 3, s33
    v_mad_u32_u24 v18, v7, s34, v6
    v_lshlrev_b32 v19, 2, v7
    v_lshlrev_b32 v9, 3, v7
    v_bfe_u32 v11, v1, 4, 1
    v_mul_u32_u24 v11, 24, v11
    v_add_u32 v11, v11, v18
    v_mov_b32 v17, 1
    s_mul_i32 s50, s31, 15360
    s_add_u32 s50, s50, 64
    v_add_u32 v23, s50, v14
    s_sub_u32 s50, s31, 1
    s_and_b32 s50, s50, 3
    s_mul_i32 s50, s50, 15360
    s_add_u32 s50, s50, 64
    v_add_u32 v20, s50, v14
    s_sub_u32 s50, s31, 2
    s_and_b32 s50, s50, 3
    s_mul_i32 s50, s50, 15360
    s_add_u32 s50, s50, 5184
    v_add_u32 v21, s50, v14
    s_sub_u32 s50, s31, 3
    s_and_b32 s50, s50, 3
    s_mul_i32 s50, s50, 15360
    s_add_u32 s50, s50, 10304
    v_add_u32 v22, s50, v14
    v_add_u32 v12, 61440, v14
    v_add_u32 v13, 112640, v14
    s_lshl_b32 s36, s29, 2
    s_add_u32 s36, s36, s31
    s_mul_i32 s36, s36, 20480
    s_lshl_b32 s50, s29, 1
    s_lshr_b32 s51, s31, 1
    s_add_u32 s50, s50, s51
    s_lshl_b32 s47, s50, 7
    s_add_u32 s47, s47, 5767168
    s_mov_b32 s40, s84
    s_mov_b32 s41, s85
    s_mov_b32 s42, 0x280000
    s_mov_b32 s43, 0x20000
    s_cmp_lg_u32 s31, 0
    s_cbranch_scc1 L_dn_noq
    s_lshr_b32 s50, s29, 2
    s_lshl_b32 s50, s50, 10
    s_add_u32 s50, s50, 5783936
    s_mul_i32 s51, s30, 80
    v_and_b32 v6, 1, v1
    v_mul_u32_u24 v6, 79, v6
    v_add_u32 v6, s51, v6
    v_and_b32 v6, 0x380, v6
    s_mov_b32 s52, 0x40000
L_dn_q:
    buffer_load_dword v7, v6, s[24:27], s50 offen sc1
    s_waitcnt vmcnt(0)
    v_cmp_eq_u32 vcc, 0, v7
    s_sub_u32 s52, s52, 1
    s_cbranch_scc1 L_dn_q_go
    s_nop 2
    s_cbranch_vccz L_dn_q_go
    s_sleep 2
    s_branch L_dn_q
L_dn_q_go:
    s_mul_i32 s50, s29, 385024
    s_mul_i32 s51, s30, 5
    s_lshr_b32 s51, s51, 1
    s_lshl_b32 s51, s51, 10
    s_add_u32 s50, s50, s51
    s_add_u32 s50, s50, 6367232
    s_mov_b32 m0, 16384
    s_nop 0
    buffer_load_dwordx4 v14, s[24:27], s50 offen offset:0 sc1 lds
    buffer_load_dwordx4 v14, s[24:27], s50 offen offset:1024 sc1 lds
    buffer_load_dwordx4 v14, s[24:27], s50 offen offset:2048 sc1 lds
    s_add_u32 s50, s50, 96256
    s_mov_b32 m0, 20480
    s_nop 0
    buffer_load_dwordx4 v14, s[24:27], s50 offen offset:0 sc1 lds
    buffer_load_dwordx4 v14, s[24:27], s50 offen offset:1024 sc1 lds
    buffer_load_dwordx4 v14, s[24:27], s50 offen offset:2048 sc1 lds
    s_add_u32 s50, s50, 96256
    s_mov_b32 m0, 24576
    s_nop 0
    buffer_load_dwordx4 v14, s[24:27], s50 offen offset:0 sc1 lds
    buffer_load_dwordx4 v14, s[24:27], s50 offen offset:1024 sc1 lds
    buffer_load_dwordx4 v14, s[24:27], s50 offen offset:2048 sc1 lds
    s_add_u32 s50, s50, 96256
    s_mov_b32 m0, 28672
    s_nop 0
    buffer_load_dwordx4 v14, s[24:27], s50 offen offset:0 sc1 lds
    buffer_load_dwordx4 v14, s[24:27], s50 offen offset:1024 sc1 lds
    buffer_load_dwordx4 v14, s[24:27], s50 offen offset:2048 sc1 lds
L_dn_noq:
    v_and_b32 v6, 7, v1
    v_lshlrev_b32 v6, 10, v6
    v_and_b32 v8, 31, v1
    v_lshlrev_b32 v8, 2, v8
    s_cmp_lg_u32 s31, 1
    s_cbranch_scc1 L_dn_nofl
L_dn_arr:
    s_sleep 2
    ds_read_b32 v7, v166 offset:12
    s_waitcnt lgkmcnt(0)
    v_readfirstlane_b32 s50, v7
    s_nop 0
    s_cmp_lt_u32 s50, 8
    s_cbranch_scc1 L_dn_arr
    s_mov_b64 exec, 1
    buffer_store_dword v17, v16, s[24:27], s86 offen sc1
    s_mov_b64 exec, -1
    s_branch L_dn_b0
L_dn_nofl:
    s_waitcnt vmcnt(0)
L_dn_b0:
    s_setprio 2
    s_barrier
    s_cmp_lg_u32 s31, 0
    s_cbranch_scc1 L_dn_noarr
    ds_write_b32 v16, v16 offset:16
    s_cmp_lg_u32 s88, 0
    s_cbranch_scc1 L_dn_nog
    s_mov_b32 s52, 0x40000
L_dn_gat:
    buffer_load_dword v7, v8, s[24:27], s87 offen sc1
    s_waitcnt vmcnt(0)
    v_cmp_eq_u32 vcc, 0, v7
    s_sub_u32 s52, s52, 1
    s_cbranch_scc1 L_dn_gat_go
    s_nop 2
    s_cbranch_vccz L_dn_gat_go
    s_sleep 2
    s_branch L_dn_gat
L_dn_gat_go:
    s_mov_b64 exec, 1
    buffer_store_dword v17, v16, s[24:27], s87 offen offset:128 sc1
    s_mov_b64 exec, -1
L_dn_nog:
    s_mov_b32 s50, 5783808
    s_mov_b32 s52, 0x40000
L_dn_all:
    buffer_load_dword v7, v6, s[24:27], s50 offen sc1
    s_waitcnt vmcnt(0)
    v_cmp_eq_u32 vcc, 0, v7
    s_sub_u32 s52, s52, 1
    s_cbranch_scc1 L_dn_all_go
    s_nop 2
    s_cbranch_vccz L_dn_all_go
    s_sleep 3
    s_branch L_dn_all
L_dn_all_go:
    ds_write_b32 v166, v17 offset:8
L_dn_noarr:
L_dn_allw:
    s_sleep 3
    ds_read_b32 v7, v166 offset:8
    s_waitcnt lgkmcnt(0)
    v_readfirstlane_b32 s50, v7
    s_nop 0
    s_cmp_eq_u32 s50, 0
    s_cbranch_scc1 L_dn_allw
    s_setprio 0
    buffer_load_dwordx4 v[44:47], v2, s[24:27], s37 offen sc1
    buffer_load_dwordx4 v[48:51], v3, s[24:27], s37 offen sc1
    buffer_load_dwordx4 v[52:55], v4, s[24:27], s37 offen sc1
    buffer_load_dwordx4 v[56:59], v5, s[24:27], s37 offen sc1
    s_add_u32 s37, s37, 4096
    buffer_load_dwordx4 v[24:27], v14, s[24:27], s38 offen offset:0 sc1
    buffer_load_dwordx4 v[28:31], v14, s[24:27], s38 offen offset:1024 sc1
    buffer_load_dwordx4 v[32:35], v14, s[24:27], s38 offen offset:2048 sc1
    buffer_load_dwordx4 v[36:39], v14, s[24:27], s38 offen offset:3072 sc1
    buffer_load_dwordx4 v[40:43], v15, s[24:27], s38 offen offset:0 sc1
    s_add_u32 s38, s38, 163840
    buffer_load_dwordx4 v[80:83], v2, s[24:27], s37 offen sc1
    buffer_load_dwordx4 v[84:87], v3, s[24:27], s37 offen sc1
    buffer_load_dwordx4 v[88:91], v4, s[24:27], s37 offen sc1
    buffer_load_dwordx4 v[92:95], v5, s[24:27], s37 offen sc1
    s_add_u32 s37, s37, 4096
    buffer_load_dwordx4 v[60:63], v14, s[24:27], s38 offen offset:0 sc1
    buffer_load_dwordx4 v[64:67], v14, s[24:27], s38 offen offset:1024 sc1
    buffer_load_dwordx4 v[68:71], v14, s[24:27], s38 offen offset:2048 sc1
    buffer_load_dwordx4 v[72:75], v14, s[24:27], s38 offen offset:3072 sc1
    buffer_load_dwordx4 v[76:79], v15, s[24:27], s38 offen offset:0 sc1
    s_add_u32 s38, s38, 163840
    s_waitcnt vmcnt(9)
    v_mfma_f32_16x16x32_bf16 v[168:171], v[24:27], v[44:47], 0
    v_mfma_f32_16x16x32_bf16 v[188:191], v[24:27], v[48:51], 0
    v_mfma_f32_16x16x32_bf16 v[208:211], v[24:27], v[52:55], 0
    v_mfma_f32_16x16x32_bf16 v[228:231], v[24:27], v[56:59], 0
    v_mfma_f32_16x16x32_bf16 v[172:175], v[28:31], v[44:47], 0
    v_mfma_f32_16x16x32_bf16 v[192:195], v[28:31], v[48:51], 0
    v_mfma_f32_16x16x32_bf16 v[212:215], v[28:31], v[52:55], 0
    v_mfma_f32_16x16x32_bf16 v[232:235], v[28:31], v[56:59], 0
    v_mfma_f32_16x16x32_bf16 v[176:179], v[32:35], v[44:47], 0
    v_mfma_f32_16x16x32_bf16 v[196:199], v[32:35], v[48:51], 0
    v_mfma_f32_16x16x32_bf16 v[216:219], v[32:35], v[52:55], 0
    v_mfma_f32_16x16x32_bf16 v[236:239], v[32:35], v[56:59], 0
    v_mfma_f32_16x16x32_bf16 v[180:183], v[36:39], v[44:47], 0
    v_mfma_f32_16x16x32_bf16 v[200:203], v[36:39], v[48:51], 0
    v_mfma_f32_16x16x32_bf16 v[220:223], v[36:39], v[52:55], 0
    v_mfma_f32_16x16x32_bf16 v[240:243], v[36:39], v[56:59], 0
    v_mfma_f32_16x16x32_bf16 v[184:187], v[40:43], v[44:47], 0
    v_mfma_f32_16x16x32_bf16 v[204:207], v[40:43], v[48:51], 0
    v_mfma_f32_16x16x32_bf16 v[224:227], v[40:43], v[52:55], 0
    v_mfma_f32_16x16x32_bf16 v[244:247], v[40:43], v[56:59], 0
    buffer_load_dwordx4 v[116:119], v2, s[24:27], s37 offen sc1
    buffer_load_dwordx4 v[120:123], v3, s[24:27], s37 offen sc1
    buffer_load_dwordx4 v[124:127], v4, s[24:27], s37 offen sc1
    buffer_load_dwordx4 v[128:131], v5, s[24:27], s37 offen sc1
    s_add_u32 s37, s37, 4096
    buffer_load_dwordx4 v[96:99], v14, s[24:27], s38 offen offset:0 sc1
    buffer_load_dwordx4 v[100:103], v14, s[24:27], s38 offen offset:1024 sc1
    buffer_load_dwordx4 v[104:107], v14, s[24:27], s38 offen offset:2048 sc1
    buffer_load_dwordx4 v[108:111], v14, s[24:27], s38 offen offset:3072 sc1
    buffer_load_dwordx4 v[112:115], v15, s[24:27], s38 offen offset:0 sc1
    s_add_u32 s38, s38, 163840
    s_waitcnt vmcnt(9)
    v_mfma_f32_16x16x32_bf16 v[168:171], v[60:63], v[80:83], v[168:171]
    v_mfma_f32_16x16x32_bf16 v[188:191], v[60:63], v[84:87], v[188:191]
    v_mfma_f32_16x16x32_bf16 v[208:211], v[60:63], v[88:91], v[208:211]
    v_mfma_f32_16x16x32_bf16 v[228:231], v[60:63], v[92:95], v[228:231]
    v_mfma_f32_16x16x32_bf16 v[172:175], v[64:67], v[80:83], v[172:175]
    v_mfma_f32_16x16x32_bf16 v[192:195], v[64:67], v[84:87], v[192:195]
    v_mfma_f32_16x16x32_bf16 v[212:215], v[64:67], v[88:91], v[212:215]
    v_mfma_f32_16x16x32_bf16 v[232:235], v[64:67], v[92:95], v[232:235]
    v_mfma_f32_16x16x32_bf16 v[176:179], v[68:71], v[80:83], v[176:179]
    v_mfma_f32_16x16x32_bf16 v[196:199], v[68:71], v[84:87], v[196:199]
    v_mfma_f32_16x16x32_bf16 v[216:219], v[68:71], v[88:91], v[216:219]
    v_mfma_f32_16x16x32_bf16 v[236:239], v[68:71], v[92:95], v[236:239]
    v_mfma_f32_16x16x32_bf16 v[180:183], v[72:75], v[80:83], v[180:183]
    v_mfma_f32_16x16x32_bf16 v[200:203], v[72:75], v[84:87], v[200:203]
    v_mfma_f32_16x16x32_bf16 v[220:223], v[72:75], v[88:91], v[220:223]
    v_mfma_f32_16x16x32_bf16 v[240:243], v[72:75], v[92:95], v[240:243]
    v_mfma_f32_16x16x32_bf16 v[184:187], v[76:79], v[80:83], v[184:187]
    v_mfma_f32_16x16x32_bf16 v[204:207], v[76:79], v[84:87], v[204:207]
    v_mfma_f32_16x16x32_bf16 v[224:227], v[76:79], v[88:91], v[224:227]
    v_mfma_f32_16x16x32_bf16 v[244:247], v[76:79], v[92:95], v[244:247]
    buffer_load_dwordx4 v[44:47], v2, s[24:27], s37 offen sc1
    buffer_load_dwordx4 v[48:51], v3, s[24:27], s37 offen sc1
    buffer_load_dwordx4 v[52:55], v4, s[24:27], s37 offen sc1
    buffer_load_dwordx4 v[56:59], v5, s[24:27], s37 offen sc1
    s_add_u32 s37, s37, 4096
    buffer_load_dwordx4 v[24:27], v14, s[24:27], s38 offen offset:0 sc1
    buffer_load_dwordx4 v[28:31], v14, s[24:27], s38 offen offset:1024 sc1
    buffer_load_dwordx4 v[32:35], v14, s[24:27], s38 offen offset:2048 sc1
    buffer_load_dwordx4 v[36:39], v14, s[24:27], s38 offen offset:3072 sc1
    buffer_load_dwordx4 v[40:43], v15, s[24:27], s38 offen offset:0 sc1
    s_add_u32 s38, s38, 163840
    s_add_u32 s50, s31, 1
    s_mul_i32 s51, s50, 40960
    s_add_u32 s51, s51, s39
    s_mul_i32 s50, s50, 5120
    s_add_u32 m0, s50, 61440
    s_nop 0
    buffer_load_dwordx4 v14, s[24:27], s51 offen offset:0 sc1 lds
    buffer_load_dwordx4 v14, s[24:27], s51 offen offset:1024 sc1 lds
    buffer_load_dwordx4 v14, s[24:27], s51 offen offset:2048 sc1 lds
    buffer_load_dwordx4 v14, s[24:27], s51 offen offset:3072 sc1 lds
    s_add_u32 m0, s50, 65536
    s_nop 0
    buffer_load_dwordx4 v15, s[24:27], s51 offen sc1 lds
    s_waitcnt vmcnt(14)
    v_mfma_f32_16x16x32_bf16 v[168:171], v[96:99], v[116:119], v[168:171]
    v_mfma_f32_16x16x32_bf16 v[188:191], v[96:99], v[120:123], v[188:191]
    v_mfma_f32_16x16x32_bf16 v[208:211], v[96:99], v[124:127], v[208:211]
    v_mfma_f32_16x16x32_bf16 v[228:231], v[96:99], v[128:131], v[228:231]
    v_mfma_f32_16x16x32_bf16 v[172:175], v[100:103], v[116:119], v[172:175]
    v_mfma_f32_16x16x32_bf16 v[192:195], v[100:103], v[120:123], v[192:195]
    v_mfma_f32_16x16x32_bf16 v[212:215], v[100:103], v[124:127], v[212:215]
    v_mfma_f32_16x16x32_bf16 v[232:235], v[100:103], v[128:131], v[232:235]
    v_mfma_f32_16x16x32_bf16 v[176:179], v[104:107], v[116:119], v[176:179]
    v_mfma_f32_16x16x32_bf16 v[196:199], v[104:107], v[120:123], v[196:199]
    v_mfma_f32_16x16x32_bf16 v[216:219], v[104:107], v[124:127], v[216:219]
    v_mfma_f32_16x16x32_bf16 v[236:239], v[104:107], v[128:131], v[236:239]
    v_mfma_f32_16x16x32_bf16 v[180:183], v[108:111], v[116:119], v[180:183]
    v_mfma_f32_16x16x32_bf16 v[200:203], v[108:111], v[120:123], v[200:203]
    v_mfma_f32_16x16x32_bf16 v[220:223], v[108:111], v[124:127], v[220:223]
    v_mfma_f32_16x16x32_bf16 v[240:243], v[108:111], v[128:131], v[240:243]
    v_mfma_f32_16x16x32_bf16 v[184:187], v[112:115], v[116:119], v[184:187]
    v_mfma_f32_16x16x32_bf16 v[204:207], v[112:115], v[120:123], v[204:207]
    v_mfma_f32_16x16x32_bf16 v[224:227], v[112:115], v[124:127], v[224:227]
    v_mfma_f32_16x16x32_bf16 v[244:247], v[112:115], v[128:131], v[244:247]
    buffer_load_dwordx4 v[80:83], v2, s[24:27], s37 offen sc1
    buffer_load_dwordx4 v[84:87], v3, s[24:27], s37 offen sc1
    buffer_load_dwordx4 v[88:91], v4, s[24:27], s37 offen sc1
    buffer_load_dwordx4 v[92:95], v5, s[24:27], s37 offen sc1
    s_add_u32 s37, s37, 4096
    buffer_load_dwordx4 v[60:63], v14, s[24:27], s38 offen offset:0 sc1
    buffer_load_dwordx4 v[64:67], v14, s[24:27], s38 offen offset:1024 sc1
    buffer_load_dwordx4 v[68:71], v14, s[24:27], s38 offen offset:2048 sc1
    buffer_load_dwordx4 v[72:75], v14, s[24:27], s38 offen offset:3072 sc1
    buffer_load_dwordx4 v[76:79], v15, s[24:27], s38 offen offset:0 sc1
    s_add_u32 s38, s38, 163840
    s_waitcnt vmcnt(14)
    v_mfma_f32_16x16x32_bf16 v[168:171], v[24:27], v[44:47], v[168:171]
    v_mfma_f32_16x16x32_bf16 v[188:191], v[24:27], v[48:51], v[188:191]
    v_mfma_f32_16x16x32_bf16 v[208:211], v[24:27], v[52:55], v[208:211]
    v_mfma_f32_16x16x32_bf16 v[228:231], v[24:27], v[56:59], v[228:231]
    v_mfma_f32_16x16x32_bf16 v[172:175], v[28:31], v[44:47], v[172:175]
    v_mfma_f32_16x16x32_bf16 v[192:195], v[28:31], v[48:51], v[192:195]
    v_mfma_f32_16x16x32_bf16 v[212:215], v[28:31], v[52:55], v[212:215]
    v_mfma_f32_16x16x32_bf16 v[232:235], v[28:31], v[56:59], v[232:235]
    v_mfma_f32_16x16x32_bf16 v[176:179], v[32:35], v[44:47], v[176:179]
    v_mfma_f32_16x16x32_bf16 v[196:199], v[32:35], v[48:51], v[196:199]
    v_mfma_f32_16x16x32_bf16 v[216:219], v[32:35], v[52:55], v[216:219]
    v_mfma_f32_16x16x32_bf16 v[236:239], v[32:35], v[56:59], v[236:239]
    v_mfma_f32_16x16x32_bf16 v[180:183], v[36:39], v[44:47], v[180:183]
    v_mfma_f32_16x16x32_bf16 v[200:203], v[36:39], v[48:51], v[200:203]
    v_mfma_f32_16x16x32_bf16 v[220:223], v[36:39], v[52:55], v[220:223]
    v_mfma_f32_16x16x32_bf16 v[240:243], v[36:39], v[56:59], v[240:243]
    v_mfma_f32_16x16x32_bf16 v[184:187], v[40:43], v[44:47], v[184:187]
    v_mfma_f32_16x16x32_bf16 v[204:207], v[40:43], v[48:51], v[204:207]
    v_mfma_f32_16x16x32_bf16 v[224:227], v[40:43], v[52:55], v[224:227]
    v_mfma_f32_16x16x32_bf16 v[244:247], v[40:43], v[56:59], v[244:247]
    buffer_load_dwordx4 v[116:119], v2, s[24:27], s37 offen sc1
    buffer_load_dwordx4 v[120:123], v3, s[24:27], s37 offen sc1
    buffer_load_dwordx4 v[124:127], v4, s[24:27], s37 offen sc1
    buffer_load_dwordx4 v[128:131], v5, s[24:27], s37 offen sc1
    s_add_u32 s37, s37, 4096
    buffer_load_dwordx4 v[96:99], v14, s[24:27], s38 offen offset:0 sc1
    buffer_load_dwordx4 v[100:103], v14, s[24:27], s38 offen offset:1024 sc1
    buffer_load_dwordx4 v[104:107], v14, s[24:27], s38 offen offset:2048 sc1
    buffer_load_dwordx4 v[108:111], v14, s[24:27], s38 offen offset:3072 sc1
    buffer_load_dwordx4 v[112:115], v15, s[24:27], s38 offen offset:0 sc1
    s_add_u32 s38, s38, 163840
    s_add_u32 s50, s31, 5
    s_mul_i32 s51, s50, 40960
    s_add_u32 s51, s51, s39
    s_mul_i32 s50, s50, 5120
    s_add_u32 m0, s50, 61440
    s_nop 0
    buffer_load_dwordx4 v14, s[24:27], s51 offen offset:0 sc1 lds
    buffer_load_dwordx4 v14, s[24:27], s51 offen offset:1024 sc1 lds
    buffer_load_dwordx4 v14, s[24:27], s51 offen offset:2048 sc1 lds
    buffer_load_dwordx4 v14, s[24:27], s51 offen offset:3072 sc1 lds
    s_add_u32 m0, s50, 65536
    s_nop 0
    buffer_load_dwordx4 v15, s[24:27], s51 offen sc1 lds
    s_waitcnt vmcnt(14)
    v_mfma_f32_16x16x32_bf16 v[168:171], v[60:63], v[80:83], v[168:171]
    v_mfma_f32_16x16x32_bf16 v[188:191], v[60:63], v[84:87], v[188:191]
    v_mfma_f32_16x16x32_bf16 v[208:211], v[60:63], v[88:91], v[208:211]
    v_mfma_f32_16x16x32_bf16 v[228:231], v[60:63], v[92:95], v[228:231]
    v_mfma_f32_16x16x32_bf16 v[172:175], v[64:67], v[80:83], v[172:175]
    v_mfma_f32_16x16x32_bf16 v[192:195], v[64:67], v[84:87], v[192:195]
    v_mfma_f32_16x16x32_bf16 v[212:215], v[64:67], v[88:91], v[212:215]
    v_mfma_f32_16x16x32_bf16 v[232:235], v[64:67], v[92:95], v[232:235]
    v_mfma_f32_16x16x32_bf16 v[176:179], v[68:71], v[80:83], v[176:179]
    v_mfma_f32_16x16x32_bf16 v[196:199], v[68:71], v[84:87], v[196:199]
    v_mfma_f32_16x16x32_bf16 v[216:219], v[68:71], v[88:91], v[216:219]
    v_mfma_f32_16x16x32_bf16 v[236:239], v[68:71], v[92:95], v[236:239]
    v_mfma_f32_16x16x32_bf16 v[180:183], v[72:75], v[80:83], v[180:183]
    v_mfma_f32_16x16x32_bf16 v[200:203], v[72:75], v[84:87], v[200:203]
    v_mfma_f32_16x16x32_bf16 v[220:223], v[72:75], v[88:91], v[220:223]
    v_mfma_f32_16x16x32_bf16 v[240:243], v[72:75], v[92:95], v[240:243]
    v_mfma_f32_16x16x32_bf16 v[184:187], v[76:79], v[80:83], v[184:187]
    v_mfma_f32_16x16x32_bf16 v[204:207], v[76:79], v[84:87], v[204:207]
    v_mfma_f32_16x16x32_bf16 v[224:227], v[76:79], v[88:91], v[224:227]
    v_mfma_f32_16x16x32_bf16 v[244:247], v[76:79], v[92:95], v[244:247]
    buffer_load_dwordx4 v[44:47], v2, s[24:27], s37 offen sc1
    buffer_load_dwordx4 v[48:51], v3, s[24:27], s37 offen sc1
    buffer_load_dwordx4 v[52:55], v4, s[24:27], s37 offen sc1
    buffer_load_dwordx4 v[56:59], v5, s[24:27], s37 offen sc1
    s_add_u32 s37, s37, 4096
    buffer_load_dwordx4 v[24:27], v14, s[24:27], s38 offen offset:0 sc1
    buffer_load_dwordx4 v[28:31], v14, s[24:27], s38 offen offset:1024 sc1
    buffer_load_dwordx4 v[32:35], v14, s[24:27], s38 offen offset:2048 sc1
    buffer_load_dwordx4 v[36:39], v14, s[24:27], s38 offen offset:3072 sc1
    buffer_load_dwordx4 v[40:43], v15, s[24:27], s38 offen offset:0 sc1
    s_add_u32 s38, s38, 163840
    s_waitcnt vmcnt(14)
    v_mfma_f32_16x16x32_bf16 v[168:171], v[96:99], v[116:119], v[168:171]
    v_mfma_f32_16x16x32_bf16 v[188:191], v[96:99], v[120:123], v[188:191]
    v_mfma_f32_16x16x32_bf16 v[208:211], v[96:99], v[124:127], v[208:211]
    v_mfma_f32_16x16x32_bf16 v[228:231], v[96:99], v[128:131], v[228:231]
    v_mfma_f32_16x16x32_bf16 v[172:175], v[100:103], v[116:119], v[172:175]
    v_mfma_f32_16x16x32_bf16 v[192:195], v[100:103], v[120:123], v[192:195]
    v_mfma_f32_16x16x32_bf16 v[212:215], v[100:103], v[124:127], v[212:215]
    v_mfma_f32_16x16x32_bf16 v[232:235], v[100:103], v[128:131], v[232:235]
    v_mfma_f32_16x16x32_bf16 v[176:179], v[104:107], v[116:119], v[176:179]
    v_mfma_f32_16x16x32_bf16 v[196:199], v[104:107], v[120:123], v[196:199]
    v_mfma_f32_16x16x32_bf16 v[216:219], v[104:107], v[124:127], v[216:219]
    v_mfma_f32_16x16x32_bf16 v[236:239], v[104:107], v[128:131], v[236:239]
    v_mfma_f32_16x16x32_bf16 v[180:183], v[108:111], v[116:119], v[180:183]
    v_mfma_f32_16x16x32_bf16 v[200:203], v[108:111], v[120:123], v[200:203]
    v_mfma_f32_16x16x32_bf16 v[220:223], v[108:111], v[124:127], v[220:223]
    v_mfma_f32_16x16x32_bf16 v[240:243], v[108:111], v[128:131], v[240:243]
    v_mfma_f32_16x16x32_bf16 v[184:187], v[112:115], v[116:119], v[184:187]
    v_mfma_f32_16x16x32_bf16 v[204:207], v[112:115], v[120:123], v[204:207]
    v_mfma_f32_16x16x32_bf16 v[224:227], v[112:115], v[124:127], v[224:227]
    v_mfma_f32_16x16x32_bf16 v[244:247], v[112:115], v[128:131], v[244:247]
    buffer_load_dwordx4 v[80:83], v2, s[24:27], s37 offen sc1
    buffer_load_dwordx4 v[84:87], v3, s[24:27], s37 offen sc1
    buffer_load_dwordx4 v[88:91], v4, s[24:27], s37 offen sc1
    buffer_load_dwordx4 v[92:95], v5, s[24:27], s37 offen sc1
    s_add_u32 s37, s37, 4096
    buffer_load_dwordx4 v[60:63], v14, s[24:27], s38 offen offset:0 sc1
    buffer_load_dwordx4 v[64:67], v14, s[24:27], s38 offen offset:1024 sc1
    buffer_load_dwordx4 v[68:71], v14, s[24:27], s38 offen offset:2048 sc1
    buffer_load_dwordx4 v[72:75], v14, s[24:27], s38 offen offset:3072 sc1
    buffer_load_dwordx4 v[76:79], v15, s[24:27], s38 offen offset:0 sc1
    s_add_u32 s38, s38, 163840
    s_add_u32 s50, s31, 9
    s_mul_i32 s51, s50, 40960
    s_add_u32 s51, s51, s39
    s_mul_i32 s50, s50, 5120
    s_add_u32 m0, s50, 61440
    s_nop 0
    buffer_load_dwordx4 v14, s[24:27], s51 offen offset:0 sc1 lds
    buffer_load_dwordx4 v14, s[24:27], s51 offen offset:1024 sc1 lds
    buffer_load_dwordx4 v14, s[24:27], s51 offen offset:2048 sc1 lds
    buffer_load_dwordx4 v14, s[24:27], s51 offen offset:3072 sc1 lds
    s_add_u32 m0, s50, 65536
    s_nop 0
    buffer_load_dwordx4 v15, s[24:27], s51 offen sc1 lds
    s_waitcnt vmcnt(14)
    v_mfma_f32_16x16x32_bf16 v[168:171], v[24:27], v[44:47], v[168:171]
    v_mfma_f32_16x16x32_bf16 v[188:191], v[24:27], v[48:51], v[188:191]
    v_mfma_f32_16x16x32_bf16 v[208:211], v[24:27], v[52:55], v[208:211]
    v_mfma_f32_16x16x32_bf16 v[228:231], v[24:27], v[56:59], v[228:231]
    v_mfma_f32_16x16x32_bf16 v[172:175], v[28:31], v[44:47], v[172:175]
    v_mfma_f32_16x16x32_bf16 v[192:195], v[28:31], v[48:51], v[192:195]
    v_mfma_f32_16x16x32_bf16 v[212:215], v[28:31], v[52:55], v[212:215]
    v_mfma_f32_16x16x32_bf16 v[232:235], v[28:31], v[56:59], v[232:235]
    v_mfma_f32_16x16x32_bf16 v[176:179], v[32:35], v[44:47], v[176:179]
    v_mfma_f32_16x16x32_bf16 v[196:199], v[32:35], v[48:51], v[196:199]
    v_mfma_f32_16x16x32_bf16 v[216:219], v[32:35], v[52:55], v[216:219]
    v_mfma_f32_16x16x32_bf16 v[236:239], v[32:35], v[56:59], v[236:239]
    v_mfma_f32_16x16x32_bf16 v[180:183], v[36:39], v[44:47], v[180:183]
    v_mfma_f32_16x16x32_bf16 v[200:203], v[36:39], v[48:51], v[200:203]
    v_mfma_f32_16x16x32_bf16 v[220:223], v[36:39], v[52:55], v[220:223]
    v_mfma_f32_16x16x32_bf16 v[240:243], v[36:39], v[56:59], v[240:243]
    v_mfma_f32_16x16x32_bf16 v[184:187], v[40:43], v[44:47], v[184:187]
    v_mfma_f32_16x16x32_bf16 v[204:207], v[40:43], v[48:51], v[204:207]
    v_mfma_f32_16x16x32_bf16 v[224:227], v[40:43], v[52:55], v[224:227]
    v_mfma_f32_16x16x32_bf16 v[244:247], v[40:43], v[56:59], v[244:247]
    buffer_load_dwordx4 v[116:119], v2, s[24:27], s37 offen sc1
    buffer_load_dwordx4 v[120:123], v3, s[24:27], s37 offen sc1
    buffer_load_dwordx4 v[124:127], v4, s[24:27], s37 offen sc1
    buffer_load_dwordx4 v[128:131], v5, s[24:27], s37 offen sc1
    s_add_u32 s37, s37, 4096
    buffer_load_dwordx4 v[96:99], v14, s[24:27], s38 offen offset:0 sc1
    buffer_load_dwordx4 v[100:103], v14, s[24:27], s38 offen offset:1024 sc1
    buffer_load_dwordx4 v[104:107], v14, s[24:27], s38 offen offset:2048 sc1
    buffer_load_dwordx4 v[108:111], v14, s[24:27], s38 offen offset:3072 sc1
    buffer_load_dwordx4 v[112:115], v15, s[24:27], s38 offen offset:0 sc1
    s_add_u32 s38, s38, 163840
    s_waitcnt vmcnt(14)
    v_mfma_f32_16x16x32_bf16 v[168:171], v[60:63], v[80:83], v[168:171]
    v_mfma_f32_16x16x32_bf16 v[188:191], v[60:63], v[84:87], v[188:191]
    v_mfma_f32_16x16x32_bf16 v[208:211], v[60:63], v[88:91], v[208:211]
    v_mfma_f32_16x16x32_bf16 v[228:231], v[60:63], v[92:95], v[228:231]
    v_mfma_f32_16x16x32_bf16 v[172:175], v[64:67], v[80:83], v[172:175]
    v_mfma_f32_16x16x32_bf16 v[192:195], v[64:67], v[84:87], v[192:195]
    v_mfma_f32_16x16x32_bf16 v[212:215], v[64:67], v[88:91], v[212:215]
    v_mfma_f32_16x16x32_bf16 v[232:235], v[64:67], v[92:95], v[232:235]
    v_mfma_f32_16x16x32_bf16 v[176:179], v[68:71], v[80:83], v[176:179]
    v_mfma_f32_16x16x32_bf16 v[196:199], v[68:71], v[84:87], v[196:199]
    v_mfma_f32_16x16x32_bf16 v[216:219], v[68:71], v[88:91], v[216:219]
    v_mfma_f32_16x16x32_bf16 v[236:239], v[68:71], v[92:95], v[236:239]
    v_mfma_f32_16x16x32_bf16 v[180:183], v[72:75], v[80:83], v[180:183]
    v_mfma_f32_16x16x32_bf16 v[200:203], v[72:75], v[84:87], v[200:203]
    v_mfma_f32_16x16x32_bf16 v[220:223], v[72:75], v[88:91], v[220:223]
    v_mfma_f32_16x16x32_bf16 v[240:243], v[72:75], v[92:95], v[240:243]
    v_mfma_f32_16x16x32_bf16 v[184:187], v[76:79], v[80:83], v[184:187]
    v_mfma_f32_16x16x32_bf16 v[204:207], v[76:79], v[84:87], v[204:207]
    v_mfma_f32_16x16x32_bf16 v[224:227], v[76:79], v[88:91], v[224:227]
    v_mfma_f32_16x16x32_bf16 v[244:247], v[76:79], v[92:95], v[244:247]
    buffer_load_dwordx4 v[44:47], v2, s[24:27], s37 offen sc1
    buffer_load_dwordx4 v[48:51], v3, s[24:27], s37 offen sc1
    buffer_load_dwordx4 v[52:55], v4, s[24:27], s37 offen sc1
    buffer_load_dwordx4 v[56:59], v5, s[24:27], s37 offen sc1
    s_add_u32 s37, s37, 4096
    buffer_load_dwordx4 v[24:27], v14, s[24:27], s38 offen offset:0 sc1
    buffer_load_dwordx4 v[28:31], v14, s[24:27], s38 offen offset:1024 sc1
    buffer_load_dwordx4 v[32:35], v14, s[24:27], s38 offen offset:2048 sc1
    buffer_load_dwordx4 v[36:39], v14, s[24:27], s38 offen offset:3072 sc1
    buffer_load_dwordx4 v[40:43], v15, s[24:27], s38 offen offset:0 sc1
    s_add_u32 s38, s38, 163840
    s_add_u32 s50, s31, 13
    s_mul_i32 s51, s50, 40960
    s_add_u32 s51, s51, s39
    s_mul_i32 s50, s50, 5120
    s_add_u32 m0, s50, 61440
    s_nop 0
    buffer_load_dwordx4 v14, s[24:27], s51 offen offset:0 sc1 lds
    buffer_load_dwordx4 v14, s[24:27], s51 offen offset:1024 sc1 lds
    buffer_load_dwordx4 v14, s[24:27], s51 offen offset:2048 sc1 lds
    buffer_load_dwordx4 v14, s[24:27], s51 offen offset:3072 sc1 lds
    s_add_u32 m0, s50, 65536
    s_nop 0
    buffer_load_dwordx4 v15, s[24:27], s51 offen sc1 lds
    s_waitcnt vmcnt(14)
    v_mfma_f32_16x16x32_bf16 v[168:171], v[96:99], v[116:119], v[168:171]
    v_mfma_f32_16x16x32_bf16 v[188:191], v[96:99], v[120:123], v[188:191]
    v_mfma_f32_16x16x32_bf16 v[208:211], v[96:99], v[124:127], v[208:211]
    v_mfma_f32_16x16x32_bf16 v[228:231], v[96:99], v[128:131], v[228:231]
    v_mfma_f32_16x16x32_bf16 v[172:175], v[100:103], v[116:119], v[172:175]
    v_mfma_f32_16x16x32_bf16 v[192:195], v[100:103], v[120:123], v[192:195]
    v_mfma_f32_16x16x32_bf16 v[212:215], v[100:103], v[124:127], v[212:215]
    v_mfma_f32_16x16x32_bf16 v[232:235], v[100:103], v[128:131], v[232:235]
    v_mfma_f32_16x16x32_bf16 v[176:179], v[104:107], v[116:119], v[176:179]
    v_mfma_f32_16x16x32_bf16 v[196:199], v[104:107], v[120:123], v[196:199]
    v_mfma_f32_16x16x32_bf16 v[216:219], v[104:107], v[124:127], v[216:219]
    v_mfma_f32_16x16x32_bf16 v[236:239], v[104:107], v[128:131], v[236:239]
    v_mfma_f32_16x16x32_bf16 v[180:183], v[108:111], v[116:119], v[180:183]
    v_mfma_f32_16x16x32_bf16 v[200:203], v[108:111], v[120:123], v[200:203]
    v_mfma_f32_16x16x32_bf16 v[220:223], v[108:111], v[124:127], v[220:223]
    v_mfma_f32_16x16x32_bf16 v[240:243], v[108:111], v[128:131], v[240:243]
    v_mfma_f32_16x16x32_bf16 v[184:187], v[112:115], v[116:119], v[184:187]
    v_mfma_f32_16x16x32_bf16 v[204:207], v[112:115], v[120:123], v[204:207]
    v_mfma_f32_16x16x32_bf16 v[224:227], v[112:115], v[124:127], v[224:227]
    v_mfma_f32_16x16x32_bf16 v[244:247], v[112:115], v[128:131], v[244:247]
    buffer_load_dwordx4 v[80:83], v2, s[24:27], s37 offen sc1
    buffer_load_dwordx4 v[84:87], v3, s[24:27], s37 offen sc1
    buffer_load_dwordx4 v[88:91], v4, s[24:27], s37 offen sc1
    buffer_load_dwordx4 v[92:95], v5, s[24:27], s37 offen sc1
    s_add_u32 s37, s37, 4096
    buffer_load_dwordx4 v[60:63], v14, s[24:27], s38 offen offset:0 sc1
    buffer_load_dwordx4 v[64:67], v14, s[24:27], s38 offen offset:1024 sc1
    buffer_load_dwordx4 v[68:71], v14, s[24:27], s38 offen offset:2048 sc1
    buffer_load_dwordx4 v[72:75], v14, s[24:27], s38 offen offset:3072 sc1
    buffer_load_dwordx4 v[76:79], v15, s[24:27], s38 offen offset:0 sc1
    s_add_u32 s38, s38, 163840
    s_waitcnt vmcnt(14)
    v_mfma_f32_16x16x32_bf16 v[168:171], v[24:27], v[44:47], v[168:171]
    v_mfma_f32_16x16x32_bf16 v[188:191], v[24:27], v[48:51], v[188:191]
    v_mfma_f32_16x16x32_bf16 v[208:211], v[24:27], v[52:55], v[208:211]
    v_mfma_f32_16x16x32_bf16 v[228:231], v[24:27], v[56:59], v[228:231]
    v_mfma_f32_16x16x32_bf16 v[172:175], v[28:31], v[44:47], v[172:175]
    v_mfma_f32_16x16x32_bf16 v[192:195], v[28:31], v[48:51], v[192:195]
    v_mfma_f32_16x16x32_bf16 v[212:215], v[28:31], v[52:55], v[212:215]
    v_mfma_f32_16x16x32_bf16 v[232:235], v[28:31], v[56:59], v[232:235]
    v_mfma_f32_16x16x32_bf16 v[176:179], v[32:35], v[44:47], v[176:179]
    v_mfma_f32_16x16x32_bf16 v[196:199], v[32:35], v[48:51], v[196:199]
    v_mfma_f32_16x16x32_bf16 v[216:219], v[32:35], v[52:55], v[216:219]
    v_mfma_f32_16x16x32_bf16 v[236:239], v[32:35], v[56:59], v[236:239]
    v_mfma_f32_16x16x32_bf16 v[180:183], v[36:39], v[44:47], v[180:183]
    v_mfma_f32_16x16x32_bf16 v[200:203], v[36:39], v[48:51], v[200:203]
    v_mfma_f32_16x16x32_bf16 v[220:223], v[36:39], v[52:55], v[220:223]
    v_mfma_f32_16x16x32_bf16 v[240:243], v[36:39], v[56:59], v[240:243]
    v_mfma_f32_16x16x32_bf16 v[184:187], v[40:43], v[44:47], v[184:187]
    v_mfma_f32_16x16x32_bf16 v[204:207], v[40:43], v[48:51], v[204:207]
    v_mfma_f32_16x16x32_bf16 v[224:227], v[40:43], v[52:55], v[224:227]
    v_mfma_f32_16x16x32_bf16 v[244:247], v[40:43], v[56:59], v[244:247]
    buffer_load_dwordx4 v[116:119], v2, s[24:27], s37 offen sc1
    buffer_load_dwordx4 v[120:123], v3, s[24:27], s37 offen sc1
    buffer_load_dwordx4 v[124:127], v4, s[24:27], s37 offen sc1
    buffer_load_dwordx4 v[128:131], v5, s[24:27], s37 offen sc1
    s_add_u32 s37, s37, 4096
    buffer_load_dwordx4 v[96:99], v14, s[24:27], s38 offen offset:0 sc1
    buffer_load_dwordx4 v[100:103], v14, s[24:27], s38 offen offset:1024 sc1
    buffer_load_dwordx4 v[104:107], v14, s[24:27], s38 offen offset:2048 sc1
    buffer_load_dwordx4 v[108:111], v14, s[24:27], s38 offen offset:3072 sc1
    buffer_load_dwordx4 v[112:115], v15, s[24:27], s38 offen offset:0 sc1
    s_add_u32 s38, s38, 163840
    s_add_u32 s50, s31, 17
    s_min_u32 s50, s50, 19
    s_mul_i32 s51, s50, 40960
    s_add_u32 s51, s51, s39
    s_mul_i32 s50, s50, 5120
    s_add_u32 m0, s50, 61440
    s_nop 0
    buffer_load_dwordx4 v14, s[24:27], s51 offen offset:0 sc1 lds
    buffer_load_dwordx4 v14, s[24:27], s51 offen offset:1024 sc1 lds
    buffer_load_dwordx4 v14, s[24:27], s51 offen offset:2048 sc1 lds
    buffer_load_dwordx4 v14, s[24:27], s51 offen offset:3072 sc1 lds
    s_add_u32 m0, s50, 65536
    s_nop 0
    buffer_load_dwordx4 v15, s[24:27], s51 offen sc1 lds
    s_waitcnt vmcnt(14)
    v_mfma_f32_16x16x32_bf16 v[168:171], v[60:63], v[80:83], v[168:171]
    v_mfma_f32_16x16x32_bf16 v[188:191], v[60:63], v[84:87], v[188:191]
    v_mfma_f32_16x16x32_bf16 v[208:211], v[60:63], v[88:91], v[208:211]
    v_mfma_f32_16x16x32_bf16 v[228:231], v[60:63], v[92:95], v[228:231]
    v_mfma_f32_16x16x32_bf16 v[172:175], v[64:67], v[80:83], v[172:175]
    v_mfma_f32_16x16x32_bf16 v[192:195], v[64:67], v[84:87], v[192:195]
    v_mfma_f32_16x16x32_bf16 v[212:215], v[64:67], v[88:91], v[212:215]
    v_mfma_f32_16x16x32_bf16 v[232:235], v[64:67], v[92:95], v[232:235]
    v_mfma_f32_16x16x32_bf16 v[176:179], v[68:71], v[80:83], v[176:179]
    v_mfma_f32_16x16x32_bf16 v[196:199], v[68:71], v[84:87], v[196:199]
    v_mfma_f32_16x16x32_bf16 v[216:219], v[68:71], v[88:91], v[216:219]
    v_mfma_f32_16x16x32_bf16 v[236:239], v[68:71], v[92:95], v[236:239]
    v_mfma_f32_16x16x32_bf16 v[180:183], v[72:75], v[80:83], v[180:183]
    v_mfma_f32_16x16x32_bf16 v[200:203], v[72:75], v[84:87], v[200:203]
    v_mfma_f32_16x16x32_bf16 v[220:223], v[72:75], v[88:91], v[220:223]
    v_mfma_f32_16x16x32_bf16 v[240:243], v[72:75], v[92:95], v[240:243]
    v_mfma_f32_16x16x32_bf16 v[184:187], v[76:79], v[80:83], v[184:187]
    v_mfma_f32_16x16x32_bf16 v[204:207], v[76:79], v[84:87], v[204:207]
    v_mfma_f32_16x16x32_bf16 v[224:227], v[76:79], v[88:91], v[224:227]
    v_mfma_f32_16x16x32_bf16 v[244:247], v[76:79], v[92:95], v[244:247]
    buffer_load_dwordx4 v[44:47], v2, s[24:27], s37 offen sc1
    buffer_load_dwordx4 v[48:51], v3, s[24:27], s37 offen sc1
    buffer_load_dwordx4 v[52:55], v4, s[24:27], s37 offen sc1
    buffer_load_dwordx4 v[56:59], v5, s[24:27], s37 offen sc1
    s_add_u32 s37, s37, 4096
    buffer_load_dwordx4 v[24:27], v14, s[24:27], s38 offen offset:0 sc1
    buffer_load_dwordx4 v[28:31], v14, s[24:27], s38 offen offset:1024 sc1
    buffer_load_dwordx4 v[32:35], v14, s[24:27], s38 offen offset:2048 sc1
    buffer_load_dwordx4 v[36:39], v14, s[24:27], s38 offen offset:3072 sc1
    buffer_load_dwordx4 v[40:43], v15, s[24:27], s38 offen offset:0 sc1
    s_add_u32 s38, s38, 163840
    s_waitcnt vmcnt(14)
    v_mfma_f32_16x16x32_bf16 v[168:171], v[96:99], v[116:119], v[168:171]
    v_mfma_f32_16x16x32_bf16 v[188:191], v[96:99], v[120:123], v[188:191]
    v_mfma_f32_16x16x32_bf16 v[208:211], v[96:99], v[124:127], v[208:211]
    v_mfma_f32_16x16x32_bf16 v[228:231], v[96:99], v[128:131], v[228:231]
    v_mfma_f32_16x16x32_bf16 v[172:175], v[100:103], v[116:119], v[172:175]
    v_mfma_f32_16x16x32_bf16 v[192:195], v[100:103], v[120:123], v[192:195]
    v_mfma_f32_16x16x32_bf16 v[212:215], v[100:103], v[124:127], v[212:215]
    v_mfma_f32_16x16x32_bf16 v[232:235], v[100:103], v[128:131], v[232:235]
    v_mfma_f32_16x16x32_bf16 v[176:179], v[104:107], v[116:119], v[176:179]
    v_mfma_f32_16x16x32_bf16 v[196:199], v[104:107], v[120:123], v[196:199]
    v_mfma_f32_16x16x32_bf16 v[216:219], v[104:107], v[124:127], v[216:219]
    v_mfma_f32_16x16x32_bf16 v[236:239], v[104:107], v[128:131], v[236:239]
    v_mfma_f32_16x16x32_bf16 v[180:183], v[108:111], v[116:119], v[180:183]
    v_mfma_f32_16x16x32_bf16 v[200:203], v[108:111], v[120:123], v[200:203]
    v_mfma_f32_16x16x32_bf16 v[220:223], v[108:111], v[124:127], v[220:223]
    v_mfma_f32_16x16x32_bf16 v[240:243], v[108:111], v[128:131], v[240:243]
    v_mfma_f32_16x16x32_bf16 v[184:187], v[112:115], v[116:119], v[184:187]
    v_mfma_f32_16x16x32_bf16 v[204:207], v[112:115], v[120:123], v[204:207]
    v_mfma_f32_16x16x32_bf16 v[224:227], v[112:115], v[124:127], v[224:227]
    v_mfma_f32_16x16x32_bf16 v[244:247], v[112:115], v[128:131], v[244:247]
    buffer_load_dwordx4 v[80:83], v2, s[24:27], s37 offen sc1
    buffer_load_dwordx4 v[84:87], v3, s[24:27], s37 offen sc1
    buffer_load_dwordx4 v[88:91], v4, s[24:27], s37 offen sc1
    buffer_load_dwordx4 v[92:95], v5, s[24:27], s37 offen sc1
    s_add_u32 s37, s37, 4096
    buffer_load_dwordx4 v[60:63], v14, s[24:27], s38 offen offset:0 sc1
    buffer_load_dwordx4 v[64:67], v14, s[24:27], s38 offen offset:1024 sc1
    buffer_load_dwordx4 v[68:71], v14, s[24:27], s38 offen offset:2048 sc1
    buffer_load_dwordx4 v[72:75], v14, s[24:27], s38 offen offset:3072 sc1
    buffer_load_dwordx4 v[76:79], v15, s[24:27], s38 offen offset:0 sc1
    s_add_u32 s38, s38, 163840
    buffer_load_dwordx2 v[156:157], v18, s[12:15], s36 offen offset:0
    buffer_load_dwordx2 v[158:159], v18, s[12:15], s36 offen offset:32
    buffer_load_dwordx2 v[160:161], v18, s[12:15], s36 offen offset:64
    buffer_load_dwordx2 v[162:163], v18, s[12:15], s36 offen offset:96
    buffer_load_dwordx2 v[164:165], v18, s[12:15], s36 offen offset:128
    s_lshl_b32 s50, s29, 2
    s_add_u32 s50, s50, s31
    s_lshl_b32 s50, s50, 7
    s_add_u32 s50, s50, 5832704
    buffer_load_dword v10, v9, s[24:27], s50 offen offset:4 sc1
    s_waitcnt vmcnt(15)
    v_mfma_f32_16x16x32_bf16 v[168:171], v[24:27], v[44:47], v[168:171]
    v_mfma_f32_16x16x32_bf16 v[188:191], v[24:27], v[48:51], v[188:191]
    v_mfma_f32_16x16x32_bf16 v[208:211], v[24:27], v[52:55], v[208:211]
    v_mfma_f32_16x16x32_bf16 v[228:231], v[24:27], v[56:59], v[228:231]
    v_mfma_f32_16x16x32_bf16 v[172:175], v[28:31], v[44:47], v[172:175]
    v_mfma_f32_16x16x32_bf16 v[192:195], v[28:31], v[48:51], v[192:195]
    v_mfma_f32_16x16x32_bf16 v[212:215], v[28:31], v[52:55], v[212:215]
    v_mfma_f32_16x16x32_bf16 v[232:235], v[28:31], v[56:59], v[232:235]
    v_mfma_f32_16x16x32_bf16 v[176:179], v[32:35], v[44:47], v[176:179]
    v_mfma_f32_16x16x32_bf16 v[196:199], v[32:35], v[48:51], v[196:199]
    v_mfma_f32_16x16x32_bf16 v[216:219], v[32:35], v[52:55], v[216:219]
    v_mfma_f32_16x16x32_bf16 v[236:239], v[32:35], v[56:59], v[236:239]
    v_mfma_f32_16x16x32_bf16 v[180:183], v[36:39], v[44:47], v[180:183]
    v_mfma_f32_16x16x32_bf16 v[200:203], v[36:39], v[48:51], v[200:203]
    v_mfma_f32_16x16x32_bf16 v[220:223], v[36:39], v[52:55], v[220:223]
    v_mfma_f32_16x16x32_bf16 v[240:243], v[36:39], v[56:59], v[240:243]
    v_mfma_f32_16x16x32_bf16 v[184:187], v[40:43], v[44:47], v[184:187]
    v_mfma_f32_16x16x32_bf16 v[204:207], v[40:43], v[48:51], v[204:207]
    v_mfma_f32_16x16x32_bf16 v[224:227], v[40:43], v[52:55], v[224:227]
    v_mfma_f32_16x16x32_bf16 v[244:247], v[40:43], v[56:59], v[244:247]
    s_waitcnt vmcnt(6)
    s_cmp_ge_u32 s31, 2
    s_cbranch_scc1 L_dn_skip
    v_mfma_f32_16x16x32_bf16 v[168:171], v[60:63], v[80:83], v[168:171]
    v_mfma_f32_16x16x32_bf16 v[188:191], v[60:63], v[84:87], v[188:191]
    v_mfma_f32_16x16x32_bf16 v[208:211], v[60:63], v[88:91], v[208:211]
    v_mfma_f32_16x16x32_bf16 v[228:231], v[60:63], v[92:95], v[228:231]
    v_mfma_f32_16x16x32_bf16 v[172:175], v[64:67], v[80:83], v[172:175]
    v_mfma_f32_16x16x32_bf16 v[192:195], v[64:67], v[84:87], v[192:195]
    v_mfma_f32_16x16x32_bf16 v[212:215], v[64:67], v[88:91], v[212:215]
    v_mfma_f32_16x16x32_bf16 v[232:235], v[64:67], v[92:95], v[232:235]
    v_mfma_f32_16x16x32_bf16 v[176:179], v[68:71], v[80:83], v[176:179]
    v_mfma_f32_16x16x32_bf16 v[196:199], v[68:71], v[84:87], v[196:199]
    v_mfma_f32_16x16x32_bf16 v[216:219], v[68:71], v[88:91], v[216:219]
    v_mfma_f32_16x16x32_bf16 v[236:239], v[68:71], v[92:95], v[236:239]
    v_mfma_f32_16x16x32_bf16 v[180:183], v[72:75], v[80:83], v[180:183]
    v_mfma_f32_16x16x32_bf16 v[200:203], v[72:75], v[84:87], v[200:203]
    v_mfma_f32_16x16x32_bf16 v[220:223], v[72:75], v[88:91], v[220:223]
    v_mfma_f32_16x16x32_bf16 v[240:243], v[72:75], v[92:95], v[240:243]
    v_mfma_f32_16x16x32_bf16 v[184:187], v[76:79], v[80:83], v[184:187]
    v_mfma_f32_16x16x32_bf16 v[204:207], v[76:79], v[84:87], v[204:207]
    v_mfma_f32_16x16x32_bf16 v[224:227], v[76:79], v[88:91], v[224:227]
    v_mfma_f32_16x16x32_bf16 v[244:247], v[76:79], v[92:95], v[244:247]
L_dn_skip:
    buffer_load_dwordx4 v[56:59], v14, s[24:27], s58 offen offset:0 sc1
    buffer_load_dwordx4 v[60:63], v14, s[24:27], s58 offen offset:1024 sc1
    buffer_load_dwordx4 v[64:67], v14, s[24:27], s58 offen offset:2048 sc1
    buffer_load_dwordx4 v[68:71], v14, s[24:27], s58 offen offset:3072 sc1
    buffer_load_dwordx4 v[72:75], v15, s[24:27], s58 offen offset:0 sc1
    s_nop 2
    ds_write_b128 v23, v[188:191] offset:0
    ds_write_b128 v23, v[192:195] offset:1024
    ds_write_b128 v23, v[196:199] offset:2048
    ds_write_b128 v23, v[200:203] offset:3072
    ds_write_b128 v23, v[204:207] offset:4096
    ds_write_b128 v23, v[208:211] offset:5120
    ds_write_b128 v23, v[212:215] offset:6144
    ds_write_b128 v23, v[216:219] offset:7168
    ds_write_b128 v23, v[220:223] offset:8192
    ds_write_b128 v23, v[224:227] offset:9216
    ds_write_b128 v23, v[228:231] offset:10240
    ds_write_b128 v23, v[232:235] offset:11264
    ds_write_b128 v23, v[236:239] offset:12288
    ds_write_b128 v23, v[240:243] offset:13312
    ds_write_b128 v23, v[244:247] offset:14336
    s_waitcnt vmcnt(5)
    s_waitcnt lgkmcnt(0)
    s_mov_b64 exec, 1
    ds_add_u32 v16, v17 offset:16
    s_mov_b64 exec, -1
L_dn_sy:
    ds_read_b32 v7, v16 offset:16
    s_waitcnt lgkmcnt(0)
    v_readfirstlane_b32 s50, v7
    s_nop 0
    s_cmp_lt_u32 s50, 4
    s_cbranch_scc1 L_dn_sy
    ds_read_b128 v[188:191], v20 offset:0
    ds_read_b128 v[192:195], v20 offset:1024
    ds_read_b128 v[196:199], v20 offset:2048
    ds_read_b128 v[200:203], v20 offset:3072
    ds_read_b128 v[204:207], v20 offset:4096
    ds_read_b128 v[208:211], v21 offset:0
    ds_read_b128 v[212:215], v21 offset:1024
    ds_read_b128 v[216:219], v21 offset:2048
    ds_read_b128 v[220:223], v21 offset:3072
    ds_read_b128 v[224:227], v21 offset:4096
    ds_read_b128 v[228:231], v22 offset:0
    ds_read_b128 v[232:235], v22 offset:1024
    ds_read_b128 v[236:239], v22 offset:2048
    ds_read_b128 v[240:243], v22 offset:3072
    ds_read_b128 v[244:247], v22 offset:4096
    ds_read_b128 v[76:79], v12 offset:5120
    ds_read_b128 v[80:83], v12 offset:6144
    ds_read_b128 v[84:87], v12 offset:7168
    ds_read_b128 v[88:91], v12 offset:8192
    ds_read_b128 v[92:95], v12 offset:9216
    ds_read_b128 v[96:99], v12 offset:10240
    ds_read_b128 v[100:103], v12 offset:11264
    ds_read_b128 v[104:107], v12 offset:12288
    ds_read_b128 v[108:111], v12 offset:13312
    ds_read_b128 v[112:115], v12 offset:14336
    ds_read_b128 v[116:119], v12 offset:15360
    ds_read_b128 v[120:123], v12 offset:16384
    ds_read_b128 v[124:127], v12 offset:17408
    ds_read_b128 v[128:131], v12 offset:18432
    ds_read_b128 v[132:135], v12 offset:19456
    ds_read_b128 v[136:139], v12 offset:20480
    ds_read_b128 v[140:143], v12 offset:21504
    ds_read_b128 v[144:147], v12 offset:22528
    ds_read_b128 v[148:151], v12 offset:23552
    ds_read_b128 v[152:155], v12 offset:24576
    s_waitcnt lgkmcnt(0)
    s_mov_b64 exec, 1
    ds_add_u32 v16, v17 offset:16
    s_mov_b64 exec, -1
    s_waitcnt vmcnt(0)
    s_barrier
    ds_read_b128 v[4:7], v16
L_dn_v:
    s_waitcnt lgkmcnt(0)
    v_or3_b32 v4, v4, v5, v6
    v_or_b32 v4, v4, v7
    s_mov_b32 s53, 0x1000
    v_readfirstlane_b32 s51, v4
    s_mov_b32 s52, 0x40000
    s_cmp_eq_u32 s51, 0
    s_barrier
    s_cbranch_scc0 L_dn_redo
    buffer_load_dword v7, v19, s[24:27], s47 offen sc1
    v_lshlrev_b32 v24, 16, v156
    v_and_b32 v25, 0xffff0000, v156
    v_lshlrev_b32 v26, 16, v157
    v_and_b32 v27, 0xffff0000, v157
    v_lshlrev_b32 v28, 16, v158
    v_and_b32 v29, 0xffff0000, v158
    v_lshlrev_b32 v30, 16, v159
    v_and_b32 v31, 0xffff0000, v159
    v_lshlrev_b32 v32, 16, v160
    v_and_b32 v33, 0xffff0000, v160
    v_lshlrev_b32 v34, 16, v161
    v_and_b32 v35, 0xffff0000, v161
    v_lshlrev_b32 v36, 16, v162
    v_and_b32 v37, 0xffff0000, v162
    v_lshlrev_b32 v38, 16, v163
    v_and_b32 v39, 0xffff0000, v163
    v_lshlrev_b32 v40, 16, v164
    v_and_b32 v41, 0xffff0000, v164
    v_lshlrev_b32 v42, 16, v165
    v_and_b32 v43, 0xffff0000, v165
    v_pk_add_f32 v[168:169], v[168:169], v[188:189]
    v_pk_add_f32 v[208:209], v[208:209], v[228:229]
    v_pk_add_f32 v[170:171], v[170:171], v[190:191]
    v_pk_add_f32 v[210:211], v[210:211], v[230:231]
    v_pk_add_f32 v[172:173], v[172:173], v[192:193]
    v_pk_add_f32 v[212:213], v[212:213], v[232:233]
    v_pk_add_f32 v[174:175], v[174:175], v[194:195]
    v_pk_add_f32 v[214:215], v[214:215], v[234:235]
    v_pk_add_f32 v[176:177], v[176:177], v[196:197]
    v_pk_add_f32 v[216:217], v[216:217], v[236:237]
    v_pk_add_f32 v[178:179], v[178:179], v[198:199]
    v_pk_add_f32 v[218:219], v[218:219], v[238:239]
    v_pk_add_f32 v[180:181], v[180:181], v[200:201]
    v_pk_add_f32 v[220:221], v[220:221], v[240:241]
    v_pk_add_f32 v[182:183], v[182:183], v[202:203]
    v_pk_add_f32 v[222:223], v[222:223], v[242:243]
    v_pk_add_f32 v[184:185], v[184:185], v[204:205]
    v_pk_add_f32 v[224:225], v[224:225], v[244:245]
    v_pk_add_f32 v[186:187], v[186:187], v[206:207]
    v_pk_add_f32 v[226:227], v[226:227], v[246:247]
    v_mul_f32 v10, v10, v10
    v_pk_add_f32 v[168:169], v[168:169], v[208:209]
    v_pk_add_f32 v[170:171], v[170:171], v[210:211]
    v_pk_add_f32 v[172:173], v[172:173], v[212:213]
    v_pk_add_f32 v[174:175], v[174:175], v[214:215]
    v_pk_add_f32 v[176:177], v[176:177], v[216:217]
    v_pk_add_f32 v[178:179], v[178:179], v[218:219]
    v_pk_add_f32 v[180:181], v[180:181], v[220:221]
    v_pk_add_f32 v[182:183], v[182:183], v[222:223]
    v_pk_add_f32 v[184:185], v[184:185], v[224:225]
    v_pk_add_f32 v[186:187], v[186:187], v[226:227]
    v_pk_fma_f32 v[168:169], v[168:169], v[10:11], v[24:25] op_sel_hi:[1,0,1]
    v_pk_fma_f32 v[170:171], v[170:171], v[10:11], v[26:27] op_sel_hi:[1,0,1]
    v_pk_fma_f32 v[172:173], v[172:173], v[10:11], v[28:29] op_sel_hi:[1,0,1]
    v_pk_fma_f32 v[174:175], v[174:175], v[10:11], v[30:31] op_sel_hi:[1,0,1]
    v_pk_fma_f32 v[176:177], v[176:177], v[10:11], v[32:33] op_sel_hi:[1,0,1]
    v_pk_fma_f32 v[178:179], v[178:179], v[10:11], v[34:35] op_sel_hi:[1,0,1]
    v_pk_fma_f32 v[180:181], v[180:181], v[10:11], v[36:37] op_sel_hi:[1,0,1]
    v_pk_fma_f32 v[182:183], v[182:183], v[10:11], v[38:39] op_sel_hi:[1,0,1]
    v_pk_fma_f32 v[184:185], v[184:185], v[10:11], v[40:41] op_sel_hi:[1,0,1]
    v_pk_fma_f32 v[186:187], v[186:187], v[10:11], v[42:43] op_sel_hi:[1,0,1]
L_dn_poll:
    s_waitcnt vmcnt(0)
    v_cmp_eq_u32 vcc, 0, v7
    s_sub_u32 s52, s52, 1
    s_cbranch_scc1 L_dn_go
    s_nop 2
    s_cbranch_vccz L_dn_go
    buffer_load_dword v7, v19, s[24:27], s47 offen sc1
    s_branch L_dn_poll
L_dn_go:
    s_mov_b32 s48, s49
    buffer_load_dwordx4 v[24:27], v2, s[24:27], s48 offen offset:0 sc1
    buffer_load_dwordx4 v[28:31], v2, s[24:27], s48 offen offset:1024 sc1
    buffer_load_dwordx4 v[32:35], v2, s[24:27], s48 offen offset:2048 sc1
    buffer_load_dwordx4 v[36:39], v2, s[24:27], s48 offen offset:3072 sc1
    s_add_u32 s48, s48, 4096
    buffer_load_dwordx4 v[40:43], v2, s[24:27], s48 offen offset:0 sc1
    buffer_load_dwordx4 v[44:47], v2, s[24:27], s48 offen offset:1024 sc1
    buffer_load_dwordx4 v[48:51], v2, s[24:27], s48 offen offset:2048 sc1
    s_waitcnt vmcnt(6)
    v_mfma_f32_16x16x32_bf16 v[188:191], v[56:59], v[24:27], v[168:171]
    ds_read_b128 v[56:59], v12 offset:25600
    buffer_load_dwordx4 v[52:55], v2, s[24:27], s48 offen offset:3072 sc1
    s_add_u32 s48, s48, 4096
    v_mfma_f32_16x16x32_bf16 v[192:195], v[60:63], v[24:27], v[172:175]
    ds_read_b128 v[60:63], v12 offset:26624
    v_mfma_f32_16x16x32_bf16 v[196:199], v[64:67], v[24:27], v[176:179]
    ds_read_b128 v[64:67], v12 offset:27648
    v_max3_u32 v8, v24, v25, v24
    v_mfma_f32_16x16x32_bf16 v[200:203], v[68:71], v[24:27], v[180:183]
    ds_read_b128 v[68:71], v12 offset:28672
    v_max3_u32 v8, v26, v27, v8
    v_mfma_f32_16x16x32_bf16 v[204:207], v[72:75], v[24:27], v[184:187]
    ds_read_b128 v[72:75], v12 offset:29696
    s_waitcnt vmcnt(6)
    v_mfma_f32_16x16x32_bf16 v[188:191], v[76:79], v[28:31], v[188:191]
    ds_read_b128 v[76:79], v12 offset:30720
    buffer_load_dwordx4 v[24:27], v2, s[24:27], s48 offen offset:0 sc1
    v_mfma_f32_16x16x32_bf16 v[192:195], v[80:83], v[28:31], v[192:195]
    ds_read_b128 v[80:83], v12 offset:31744
    v_mfma_f32_16x16x32_bf16 v[196:199], v[84:87], v[28:31], v[196:199]
    ds_read_b128 v[84:87], v12 offset:32768
    v_max3_u32 v8, v28, v29, v8
    v_mfma_f32_16x16x32_bf16 v[200:203], v[88:91], v[28:31], v[200:203]
    ds_read_b128 v[88:91], v12 offset:33792
    v_max3_u32 v8, v30, v31, v8
    v_mfma_f32_16x16x32_bf16 v[204:207], v[92:95], v[28:31], v[204:207]
    ds_read_b128 v[92:95], v12 offset:34816
    s_waitcnt vmcnt(6)
    v_mfma_f32_16x16x32_bf16 v[188:191], v[96:99], v[32:35], v[188:191]
    ds_read_b128 v[96:99], v12 offset:35840
    buffer_load_dwordx4 v[28:31], v2, s[24:27], s48 offen offset:1024 sc1
    v_mfma_f32_16x16x32_bf16 v[192:195], v[100:103], v[32:35], v[192:195]
    ds_read_b128 v[100:103], v12 offset:36864
    v_mfma_f32_16x16x32_bf16 v[196:199], v[104:107], v[32:35], v[196:199]
    ds_read_b128 v[104:107], v12 offset:37888
    v_max3_u32 v8, v32, v33, v8
    v_mfma_f32_16x16x32_bf16 v[200:203], v[108:111], v[32:35], v[200:203]
    ds_read_b128 v[108:111], v12 offset:38912
    v_max3_u32 v8, v34, v35, v8
    v_mfma_f32_16x16x32_bf16 v[204:207], v[112:115], v[32:35], v[204:207]
    ds_read_b128 v[112:115], v12 offset:39936
    s_waitcnt vmcnt(6)
    v_mfma_f32_16x16x32_bf16 v[188:191], v[116:119], v[36:39], v[188:191]
    ds_read_b128 v[116:119], v12 offset:40960
    s_mov_b32 s48, s55
    buffer_load_dwordx4 v[32:35], v2, s[24:27], s48 offen offset:0 sc1
    v_mfma_f32_16x16x32_bf16 v[192:195], v[120:123], v[36:39], v[192:195]
    ds_read_b128 v[120:123], v12 offset:41984
    v_mfma_f32_16x16x32_bf16 v[196:199], v[124:127], v[36:39], v[196:199]
    ds_read_b128 v[124:127], v12 offset:43008
    v_max3_u32 v8, v36, v37, v8
    v_mfma_f32_16x16x32_bf16 v[200:203], v[128:131], v[36:39], v[200:203]
    ds_read_b128 v[128:131], v12 offset:44032
    v_max3_u32 v8, v38, v39, v8
    v_mfma_f32_16x16x32_bf16 v[204:207], v[132:135], v[36:39], v[204:207]
    ds_read_b128 v[132:135], v12 offset:45056
    s_waitcnt vmcnt(6)
    v_mfma_f32_16x16x32_bf16 v[188:191], v[136:139], v[40:43], v[188:191]
    ds_read_b128 v[136:139], v12 offset:46080
    buffer_load_dwordx4 v[36:39], v2, s[24:27], s48 offen offset:1024 sc1
    v_mfma_f32_16x16x32_bf16 v[192:195], v[140:143], v[40:43], v[192:195]
    ds_read_b128 v[140:143], v12 offset:47104
    v_mfma_f32_16x16x32_bf16 v[196:199], v[144:147], v[40:43], v[196:199]
    ds_read_b128 v[144:147], v12 offset:48128
    v_max3_u32 v8, v40, v41, v8
    v_mfma_f32_16x16x32_bf16 v[200:203], v[148:151], v[40:43], v[200:203]
    ds_read_b128 v[148:151], v12 offset:49152
    v_max3_u32 v8, v42, v43, v8
    v_mfma_f32_16x16x32_bf16 v[204:207], v[152:155], v[40:43], v[204:207]
    ds_read_b128 v[152:155], v12 offset:50176
    s_waitcnt lgkmcnt(15)
    s_waitcnt vmcnt(6)
    v_mfma_f32_16x16x32_bf16 v[188:191], v[56:59], v[44:47], v[188:191]
    ds_read_b128 v[56:59], v13 offset:0
    buffer_load_dwordx4 v[40:43], v2, s[24:27], s48 offen offset:2048 sc1
    v_mfma_f32_16x16x32_bf16 v[192:195], v[60:63], v[44:47], v[192:195]
    ds_read_b128 v[60:63], v13 offset:1024
    v_mfma_f32_16x16x32_bf16 v[196:199], v[64:67], v[44:47], v[196:199]
    ds_read_b128 v[64:67], v13 offset:2048
    v_max3_u32 v8, v44, v45, v8
    v_mfma_f32_16x16x32_bf16 v[200:203], v[68:71], v[44:47], v[200:203]
    ds_read_b128 v[68:71], v13 offset:3072
    v_max3_u32 v8, v46, v47, v8
    v_mfma_f32_16x16x32_bf16 v[204:207], v[72:75], v[44:47], v[204:207]
    ds_read_b128 v[72:75], v13 offset:4096
    s_waitcnt vmcnt(6)
    v_mfma_f32_16x16x32_bf16 v[188:191], v[76:79], v[48:51], v[188:191]
    ds_read_b128 v[76:79], v13 offset:5120
    buffer_load_dwordx4 v[44:47], v2, s[24:27], s48 offen offset:3072 sc1
    s_add_u32 s48, s48, 4096
    v_mfma_f32_16x16x32_bf16 v[192:195], v[80:83], v[48:51], v[192:195]
    ds_read_b128 v[80:83], v13 offset:6144
    v_mfma_f32_16x16x32_bf16 v[196:199], v[84:87], v[48:51], v[196:199]
    ds_read_b128 v[84:87], v13 offset:7168
    v_max3_u32 v8, v48, v49, v8
    v_mfma_f32_16x16x32_bf16 v[200:203], v[88:91], v[48:51], v[200:203]
    ds_read_b128 v[88:91], v13 offset:8192
    v_max3_u32 v8, v50, v51, v8
    v_mfma_f32_16x16x32_bf16 v[204:207], v[92:95], v[48:51], v[204:207]
    ds_read_b128 v[92:95], v13 offset:9216
    s_waitcnt lgkmcnt(15)
    s_waitcnt vmcnt(6)
    v_mfma_f32_16x16x32_bf16 v[188:191], v[96:99], v[52:55], v[188:191]
    ds_read_b128 v[96:99], v13 offset:10240
    buffer_load_dwordx4 v[48:51], v2, s[24:27], s48 offen offset:0 sc1
    v_mfma_f32_16x16x32_bf16 v[192:195], v[100:103], v[52:55], v[192:195]
    ds_read_b128 v[100:103], v13 offset:11264
    v_mfma_f32_16x16x32_bf16 v[196:199], v[104:107], v[52:55], v[196:199]
    ds_read_b128 v[104:107], v13 offset:12288
    v_max3_u32 v8, v52, v53, v8
    v_mfma_f32_16x16x32_bf16 v[200:203], v[108:111], v[52:55], v[200:203]
    ds_read_b128 v[108:111], v13 offset:13312
    v_max3_u32 v8, v54, v55, v8
    v_mfma_f32_16x16x32_bf16 v[204:207], v[112:115], v[52:55], v[204:207]
    ds_read_b128 v[112:115], v13 offset:14336
    s_waitcnt vmcnt(6)
    v_mfma_f32_16x16x32_bf16 v[188:191], v[116:119], v[24:27], v[188:191]
    ds_read_b128 v[116:119], v13 offset:15360
    buffer_load_dwordx4 v[52:55], v2, s[24:27], s48 offen offset:1024 sc1
    v_mfma_f32_16x16x32_bf16 v[192:195], v[120:123], v[24:27], v[192:195]
    ds_read_b128 v[120:123], v13 offset:16384
    v_mfma_f32_16x16x32_bf16 v[196:199], v[124:127], v[24:27], v[196:199]
    ds_read_b128 v[124:127], v13 offset:17408
    v_max3_u32 v8, v24, v25, v8
    v_mfma_f32_16x16x32_bf16 v[200:203], v[128:131], v[24:27], v[200:203]
    ds_read_b128 v[128:131], v13 offset:18432
    v_max3_u32 v8, v26, v27, v8
    v_mfma_f32_16x16x32_bf16 v[204:207], v[132:135], v[24:27], v[204:207]
    ds_read_b128 v[132:135], v13 offset:19456
    s_waitcnt lgkmcnt(15)
    s_waitcnt vmcnt(6)
    v_mfma_f32_16x16x32_bf16 v[188:191], v[136:139], v[28:31], v[188:191]
    ds_read_b128 v[136:139], v13 offset:20480
    buffer_load_dwordx4 v[24:27], v2, s[24:27], s48 offen offset:2048 sc1
    v_mfma_f32_16x16x32_bf16 v[192:195], v[140:143], v[28:31], v[192:195]
    ds_read_b128 v[140:143], v13 offset:21504
    v_mfma_f32_16x16x32_bf16 v[196:199], v[144:147], v[28:31], v[196:199]
    ds_read_b128 v[144:147], v13 offset:22528
    v_max3_u32 v8, v28, v29, v8
    v_mfma_f32_16x16x32_bf16 v[200:203], v[148:151], v[28:31], v[200:203]
    ds_read_b128 v[148:151], v13 offset:23552
    v_max3_u32 v8, v30, v31, v8
    v_mfma_f32_16x16x32_bf16 v[204:207], v[152:155], v[28:31], v[204:207]
    ds_read_b128 v[152:155], v13 offset:24576
    s_waitcnt vmcnt(6)
    v_mfma_f32_16x16x32_bf16 v[188:191], v[56:59], v[32:35], v[188:191]
    ds_read_b128 v[56:59], v13 offset:25600
    buffer_load_dwordx4 v[28:31], v2, s[24:27], s48 offen offset:3072 sc1
    s_add_u32 s48, s48, 4096
    v_mfma_f32_16x16x32_bf16 v[192:195], v[60:63], v[32:35], v[192:195]
    ds_read_b128 v[60:63], v13 offset:26624
    v_mfma_f32_16x16x32_bf16 v[196:199], v[64:67], v[32:35], v[196:199]
    ds_read_b128 v[64:67], v13 offset:27648
    v_max3_u32 v8, v32, v33, v8
    v_mfma_f32_16x16x32_bf16 v[200:203], v[68:71], v[32:35], v[200:203]
    ds_read_b128 v[68:71], v13 offset:28672
    v_max3_u32 v8, v34, v35, v8
    v_mfma_f32_16x16x32_bf16 v[204:207], v[72:75], v[32:35], v[204:207]
    ds_read_b128 v[72:75], v13 offset:29696
    s_waitcnt lgkmcnt(15)
    s_waitcnt vmcnt(6)
    v_mfma_f32_16x16x32_bf16 v[188:191], v[76:79], v[36:39], v[188:191]
    ds_read_b128 v[76:79], v13 offset:30720
    buffer_load_dwordx4 v[32:35], v2, s[24:27], s48 offen offset:0 sc1
    v_mfma_f32_16x16x32_bf16 v[192:195], v[80:83], v[36:39], v[192:195]
    ds_read_b128 v[80:83], v13 offset:31744
    v_mfma_f32_16x16x32_bf16 v[196:199], v[84:87], v[36:39], v[196:199]
    ds_read_b128 v[84:87], v13 offset:32768
    v_max3_u32 v8, v36, v37, v8
    v_mfma_f32_16x16x32_bf16 v[200:203], v[88:91], v[36:39], v[200:203]
    ds_read_b128 v[88:91], v13 offset:33792
    v_max3_u32 v8, v38, v39, v8
    v_mfma_f32_16x16x32_bf16 v[204:207], v[92:95], v[36:39], v[204:207]
    ds_read_b128 v[92:95], v13 offset:34816
    s_waitcnt vmcnt(6)
    v_mfma_f32_16x16x32_bf16 v[188:191], v[96:99], v[40:43], v[188:191]
    ds_read_b128 v[96:99], v13 offset:35840
    buffer_load_dwordx4 v[36:39], v2, s[24:27], s48 offen offset:1024 sc1
    v_mfma_f32_16x16x32_bf16 v[192:195], v[100:103], v[40:43], v[192:195]
    ds_read_b128 v[100:103], v13 offset:36864
    v_mfma_f32_16x16x32_bf16 v[196:199], v[104:107], v[40:43], v[196:199]
    ds_read_b128 v[104:107], v13 offset:37888
    v_max3_u32 v8, v40, v41, v8
    v_mfma_f32_16x16x32_bf16 v[200:203], v[108:111], v[40:43], v[200:203]
    ds_read_b128 v[108:111], v13 offset:38912
    v_max3_u32 v8, v42, v43, v8
    v_mfma_f32_16x16x32_bf16 v[204:207], v[112:115], v[40:43], v[204:207]
    ds_read_b128 v[112:115], v13 offset:39936
    s_waitcnt lgkmcnt(15)
    s_waitcnt vmcnt(6)
    v_mfma_f32_16x16x32_bf16 v[188:191], v[116:119], v[44:47], v[188:191]
    ds_read_b128 v[116:119], v13 offset:40960
    v_mfma_f32_16x16x32_bf16 v[192:195], v[120:123], v[44:47], v[192:195]
    ds_read_b128 v[120:123], v13 offset:41984
    v_mfma_f32_16x16x32_bf16 v[196:199], v[124:127], v[44:47], v[196:199]
    ds_read_b128 v[124:127], v13 offset:43008
    v_max3_u32 v8, v44, v45, v8
    v_mfma_f32_16x16x32_bf16 v[200:203], v[128:131], v[44:47], v[200:203]
    ds_read_b128 v[128:131], v13 offset:44032
    v_max3_u32 v8, v46, v47, v8
    v_mfma_f32_16x16x32_bf16 v[204:207], v[132:135], v[44:47], v[204:207]
    ds_read_b128 v[132:135], v13 offset:45056
    s_waitcnt vmcnt(5)
    v_mfma_f32_16x16x32_bf16 v[188:191], v[136:139], v[48:51], v[188:191]
    ds_read_b128 v[136:139], v13 offset:46080
    v_mfma_f32_16x16x32_bf16 v[192:195], v[140:143], v[48:51], v[192:195]
    ds_read_b128 v[140:143], v13 offset:47104
    v_mfma_f32_16x16x32_bf16 v[196:199], v[144:147], v[48:51], v[196:199]
    ds_read_b128 v[144:147], v13 offset:48128
    v_max3_u32 v8, v48, v49, v8
    v_mfma_f32_16x16x32_bf16 v[200:203], v[148:151], v[48:51], v[200:203]
    ds_read_b128 v[148:151], v13 offset:49152
    v_max3_u32 v8, v50, v51, v8
    v_mfma_f32_16x16x32_bf16 v[204:207], v[152:155], v[48:51], v[204:207]
    ds_read_b128 v[152:155], v13 offset:50176
    s_waitcnt lgkmcnt(15)
    s_waitcnt vmcnt(4)
    v_mfma_f32_16x16x32_bf16 v[188:191], v[56:59], v[52:55], v[188:191]
    v_mfma_f32_16x16x32_bf16 v[192:195], v[60:63], v[52:55], v[192:195]
    v_mfma_f32_16x16x32_bf16 v[196:199], v[64:67], v[52:55], v[196:199]
    v_max3_u32 v8, v52, v53, v8
    v_mfma_f32_16x16x32_bf16 v[200:203], v[68:71], v[52:55], v[200:203]
    v_max3_u32 v8, v54, v55, v8
    v_mfma_f32_16x16x32_bf16 v[204:207], v[72:75], v[52:55], v[204:207]
    s_waitcnt vmcnt(3)
    v_mfma_f32_16x16x32_bf16 v[188:191], v[76:79], v[24:27], v[188:191]
    v_mfma_f32_16x16x32_bf16 v[192:195], v[80:83], v[24:27], v[192:195]
    v_mfma_f32_16x16x32_bf16 v[196:199], v[84:87], v[24:27], v[196:199]
    v_max3_u32 v8, v24, v25, v8
    v_mfma_f32_16x16x32_bf16 v[200:203], v[88:91], v[24:27], v[200:203]
    v_max3_u32 v8, v26, v27, v8
    v_mfma_f32_16x16x32_bf16 v[204:207], v[92:95], v[24:27], v[204:207]
    s_waitcnt lgkmcnt(14)
    s_waitcnt vmcnt(2)
    v_mfma_f32_16x16x32_bf16 v[188:191], v[96:99], v[28:31], v[188:191]
    s_waitcnt lgkmcnt(13)
    v_mfma_f32_16x16x32_bf16 v[192:195], v[100:103], v[28:31], v[192:195]
    s_waitcnt lgkmcnt(12)
    v_mfma_f32_16x16x32_bf16 v[196:199], v[104:107], v[28:31], v[196:199]
    v_max3_u32 v8, v28, v29, v8
    s_waitcnt lgkmcnt(11)
    v_mfma_f32_16x16x32_bf16 v[200:203], v[108:111], v[28:31], v[200:203]
    v_max3_u32 v8, v30, v31, v8
    s_waitcnt lgkmcnt(10)
    v_mfma_f32_16x16x32_bf16 v[204:207], v[112:115], v[28:31], v[204:207]
    s_waitcnt lgkmcnt(9)
    s_waitcnt vmcnt(1)
    v_mfma_f32_16x16x32_bf16 v[188:191], v[116:119], v[32:35], v[188:191]
    s_waitcnt lgkmcnt(8)
    v_mfma_f32_16x16x32_bf16 v[192:195], v[120:123], v[32:35], v[192:195]
    s_waitcnt lgkmcnt(7)
    v_mfma_f32_16x16x32_bf16 v[196:199], v[124:127], v[32:35], v[196:199]
    v_max3_u32 v8, v32, v33, v8
    s_waitcnt lgkmcnt(6)
    v_mfma_f32_16x16x32_bf16 v[200:203], v[128:131], v[32:35], v[200:203]
    v_max3_u32 v8, v34, v35, v8
    s_waitcnt lgkmcnt(5)
    v_mfma_f32_16x16x32_bf16 v[204:207], v[132:135], v[32:35], v[204:207]
    s_waitcnt lgkmcnt(4)
    s_waitcnt vmcnt(0)
    v_mfma_f32_16x16x32_bf16 v[188:191], v[136:139], v[36:39], v[188:191]
    s_waitcnt lgkmcnt(3)
    v_mfma_f32_16x16x32_bf16 v[192:195], v[140:143], v[36:39], v[192:195]
    s_waitcnt lgkmcnt(2)
    v_mfma_f32_16x16x32_bf16 v[196:199], v[144:147], v[36:39], v[196:199]
    v_max3_u32 v8, v36, v37, v8
    s_waitcnt lgkmcnt(1)
    v_mfma_f32_16x16x32_bf16 v[200:203], v[148:151], v[36:39], v[200:203]
    v_max3_u32 v8, v38, v39, v8
    s_waitcnt lgkmcnt(0)
    v_mfma_f32_16x16x32_bf16 v[204:207], v[152:155], v[36:39], v[204:207]
L_dn_fin:
    v_cmp_eq_u32 vcc, -1, v8
    s_nop 2
    v_cvt_pk_bf16_f32 v24, v188, v189
    v_cvt_pk_bf16_f32 v25, v190, v191
    s_cbranch_vccnz L_dn_again
L_dn_out:
    v_cvt_pk_bf16_f32 v26, v192, v193
    v_cvt_pk_bf16_f32 v27, v194, v195
    v_cvt_pk_bf16_f32 v28, v196, v197
    v_cvt_pk_bf16_f32 v29, v198, v199
    v_permlane16_swap_b32 v24, v26
    v_permlane16_swap_b32 v25, v27
    v_cvt_pk_bf16_f32 v30, v200, v201
    v_cvt_pk_bf16_f32 v31, v202, v203
    buffer_store_dwordx4 v[24:27], v11, s[40:43], s36 offen
    v_cvt_pk_bf16_f32 v32, v204, v205
    v_cvt_pk_bf16_f32 v33, v206, v207
    v_permlane16_swap_b32 v28, v30
    v_permlane16_swap_b32 v29, v31
    buffer_store_dwordx2 v[32:33], v18, s[40:43], s36 offen offset:128
    buffer_store_dwordx4 v[28:31], v11, s[40:43], s36 offen offset:64
    s_endpgm
L_dn_redo:
    s_barrier
    ds_read_b128 v[4:7], v16
    s_branch L_dn_v
L_dn_again:
    s_sub_u32 s53, s53, 1
    s_cbranch_scc1 L_dn_out
    s_mov_b32 s50, s58
    buffer_load_dwordx4 v[56:59], v14, s[24:27], s50 offen offset:0 sc1
    buffer_load_dwordx4 v[60:63], v14, s[24:27], s50 offen offset:1024 sc1
    buffer_load_dwordx4 v[64:67], v14, s[24:27], s50 offen offset:2048 sc1
    buffer_load_dwordx4 v[68:71], v14, s[24:27], s50 offen offset:3072 sc1
    buffer_load_dwordx4 v[72:75], v15, s[24:27], s50 offen offset:0 sc1
    s_add_u32 s50, s50, 40960
    buffer_load_dwordx4 v[76:79], v14, s[24:27], s50 offen offset:0 sc1
    buffer_load_dwordx4 v[80:83], v14, s[24:27], s50 offen offset:1024 sc1
    buffer_load_dwordx4 v[84:87], v14, s[24:27], s50 offen offset:2048 sc1
    buffer_load_dwordx4 v[88:91], v14, s[24:27], s50 offen offset:3072 sc1
    buffer_load_dwordx4 v[92:95], v15, s[24:27], s50 offen offset:0 sc1
    s_add_u32 s50, s50, 40960
    buffer_load_dwordx4 v[96:99], v14, s[24:27], s50 offen offset:0 sc1
    buffer_load_dwordx4 v[100:103], v14, s[24:27], s50 offen offset:1024 sc1
    buffer_load_dwordx4 v[104:107], v14, s[24:27], s50 offen offset:2048 sc1
    buffer_load_dwordx4 v[108:111], v14, s[24:27], s50 offen offset:3072 sc1
    buffer_load_dwordx4 v[112:115], v15, s[24:27], s50 offen offset:0 sc1
    s_add_u32 s50, s50, 40960
    buffer_load_dwordx4 v[116:119], v14, s[24:27], s50 offen offset:0 sc1
    buffer_load_dwordx4 v[120:123], v14, s[24:27], s50 offen offset:1024 sc1
    buffer_load_dwordx4 v[124:127], v14, s[24:27], s50 offen offset:2048 sc1
    buffer_load_dwordx4 v[128:131], v14, s[24:27], s50 offen offset:3072 sc1
    buffer_load_dwordx4 v[132:135], v15, s[24:27], s50 offen offset:0 sc1
    s_add_u32 s50, s50, 40960
    buffer_load_dwordx4 v[136:139], v14, s[24:27], s50 offen offset:0 sc1
    buffer_load_dwordx4 v[140:143], v14, s[24:27], s50 offen offset:1024 sc1
    buffer_load_dwordx4 v[144:147], v14, s[24:27], s50 offen offset:2048 sc1
    buffer_load_dwordx4 v[148:151], v14, s[24:27], s50 offen offset:3072 sc1
    buffer_load_dwordx4 v[152:155], v15, s[24:27], s50 offen offset:0 sc1
    s_add_u32 s50, s50, 40960
    s_waitcnt vmcnt(0)
    s_branch L_dn_go
L_m_done:
    s_endpgm
.section .rodata,"a"
.p2align 6
.amdhsa_kernel parallel_sum__grouped_kv_mqa__glu_gated_reglu__prompt_kernel
  .amdhsa_next_free_vgpr 256
  .amdhsa_next_free_sgpr 96
  .amdhsa_accum_offset 256
  .amdhsa_group_segment_fixed_size 0
  .amdhsa_kernarg_size 96
  .amdhsa_user_sgpr_count 2
  .amdhsa_user_sgpr_kernarg_segment_ptr 1
  .amdhsa_system_sgpr_workgroup_id_x 1
.end_amdhsa_kernel
.text
L_code_end:
    s_endpgm
```
